```python
import torch

def _softmax(x, axis=-1):
    return torch.softmax(x, dim=axis)
def _gelu(x):
    return torch.nn.functional.gelu(x, approximate="tanh")
def _silu(x):
    return torch.nn.functional.silu(x)
def _sigmoid(x):
    return torch.sigmoid(x)
def _layernorm(x, axis=-1, eps=1e-5):
    m = x.mean(dim=axis, keepdim=True)
    v = x.var(dim=axis, keepdim=True, unbiased=False)
    return (x - m) / torch.sqrt(v + eps)
def _scatter_add(tgt, idx, src, axis=0):
    return tgt.clone().index_add_(axis, idx, src)
def _segment_sum(src, seg, n):
    out = torch.zeros((n,) + src.shape[1:], dtype=src.dtype)
    return out.index_add_(0, seg, src)
def _pad(x, pw):
    flat = tuple(v for pair in reversed(pw) for v in pair)
    return torch.nn.functional.pad(x, flat)

kernel_name = 'standalone__deep_cross_pnn__recsys'

def setup_inputs():

    _w = (lambda a: (lambda t: t.to(torch.bfloat16) if t.is_floating_point() else t)(torch.as_tensor(a)))
    B, F, D, V = 4096, 100, 32, min(1000000, 100000)
    H = 4 * D
    return {
        "idx": _w((lambda lo, hi, *s: torch.randint(lo, hi, s))(0, V, B, F).to(torch.int64)),
        "table": _w((lambda *s: torch.randn(*s, dtype=torch.bfloat16) * 1.6)(V, D) * (D ** -0.5)),
        "w_p": _w((lambda *s: torch.randn(*s, dtype=torch.bfloat16) * 0.05)(F * F) * ((F * F) ** -0.5)),
        "w1": _w((lambda *s: torch.randn(*s, dtype=torch.bfloat16) * 1.6)(F * D, H) * ((F * D) ** -0.5)),
        "b1": _w((lambda *s: torch.randn(*s, dtype=torch.bfloat16) * 1.6)(H) * 0.01),
        "w2": _w((lambda *s: torch.randn(*s, dtype=torch.bfloat16) * 0.05)(H) * (H ** -0.5)),
        "b2": _w((lambda *s: torch.randn(*s, dtype=torch.bfloat16) * 0.05)(1) * 0.01),
    }

def reference(idx, table, w_p, w1, b1, w2, b2):
    emb = table[idx]
    B = emb.shape[0]; F = emb.shape[1]; D = emb.shape[2]
    ip = torch.einsum('bid,bjd->bij', emb, emb)
    ip = ip.reshape(B, F * F)
    logit_p = ip @ w_p
    z = emb.reshape(B, F * D)
    h = _gelu(z @ w1 + b1)
    logit_d = h @ w2 + b2
    return logit_p + logit_d
```

```asm
; @launch grid=(256,1,1) block=(512,1,1) lds=159488
.amdgcn_target "amdgcn-amd-amdhsa--gfx950"
.text
.globl standalone__deep_cross_pnn__recsys_kernel
.p2align 8
.type standalone__deep_cross_pnn__recsys_kernel,@function
standalone__deep_cross_pnn__recsys_kernel:
    s_cmp_ge_u32 s2, 256
    s_cbranch_scc1 L_end
    s_load_dwordx16 s[4:19], s[0:1], 0
    s_load_dwordx4 s[64:67], s[0:1], 64
    v_lshrrev_b32 v2, 6, v0
    v_and_b32 v1, 63, v0
    v_and_b32 v5, 15, v0
    v_readfirstlane_b32 s3, v2
    v_lshrrev_b32 v6, 4, v1
    s_lshr_b32 s63, s2, 4
    s_lshl_b32 s63, s63, 3
    s_and_b32 s68, s2, 7
    s_add_u32 s69, s63, s68
    s_lshr_b32 s70, s2, 3
    s_and_b32 s70, s70, 1
    s_lshl_b32 s63, s69, 5
    s_lshl_b32 s68, s70, 4
    s_add_u32 s56, s63, s68
    s_xor_b32 s68, s68, 16
    s_add_u32 s59, s63, s68
    s_and_b32 s57, s3, 3
    s_lshr_b32 s63, s2, 4
    s_mul_i32 s68, s63, 43
    s_lshr_b32 s68, s68, 8
    s_mul_i32 s68, s68, 6
    s_sub_u32 s73, s63, s68
    s_mov_b32 s60, 0x05040100
    s_mov_b32 s61, 0x07060302
    s_mov_b32 s62, 0xffff0000
    s_cmp_ge_u32 s3, 4
    s_cbranch_scc1 L_M0
    s_setprio 3
    v_lshrrev_b32 v2, 2, v1
    v_add_u32 v3, s56, v2
    s_branch L_M1
L_M0:
    v_add_u32 v3, s59, v5
L_M1:
    v_mul_u32_u24 v9, 400, v3
    s_lshl_b32 s63, s57, 4
    v_add_u32 v9, s63, v9
    s_lshl_b32 s75, s73, 6
    v_lshlrev_b32 v7, 4, v1
    s_mov_b32 s26, 1638400
    s_mov_b32 s27, 0x20000
    s_mov_b32 s34, 20004
    s_mov_b32 s35, 0x20000
    s_lshl_b32 s63, s69, 5
    s_mul_i32 s71, s63, 400
    s_lshl_b32 s72, s57, 10
    s_add_u32 s71, s71, s72
    s_waitcnt lgkmcnt(0)
    s_mov_b32 s24, s4
    s_mov_b32 s25, s5
    s_mov_b32 s32, s8
    s_mov_b32 s33, s9
    buffer_load_dwordx4 v[176:179], v9, s[24:27], s75 offen
    s_cmp_ge_u32 s3, 4
    s_cbranch_scc1 L_nostage
    s_add_u32 m0, s72, 125696
    s_add_u32 s63, s71, 0
    buffer_load_dwordx4 v7, s[24:27], s63 offen lds
    s_add_u32 m0, s72, 129792
    s_add_u32 s63, s71, 4096
    buffer_load_dwordx4 v7, s[24:27], s63 offen lds
    s_add_u32 m0, s72, 133888
    s_add_u32 s63, s71, 8192
    buffer_load_dwordx4 v7, s[24:27], s63 offen lds
    s_cmp_lg_u32 s3, 0
    s_cbranch_scc1 L_noidx2
    s_mov_b32 m0, 137984
    s_add_u32 s63, s71, 12288
    s_mov_b32 exec_hi, 0
    buffer_load_dwordx4 v7, s[24:27], s63 offen lds
    s_mov_b32 exec_hi, -1
L_noidx2:
    s_add_u32 m0, s72, 138496
    s_add_u32 s63, s72, 0
    buffer_load_dwordx4 v7, s[32:35], s63 offen lds
    s_add_u32 m0, s72, 142592
    s_add_u32 s63, s72, 4096
    buffer_load_dwordx4 v7, s[32:35], s63 offen lds
    s_add_u32 m0, s72, 146688
    s_add_u32 s63, s72, 8192
    buffer_load_dwordx4 v7, s[32:35], s63 offen lds
    s_add_u32 m0, s72, 150784
    s_add_u32 s63, s72, 12288
    buffer_load_dwordx4 v7, s[32:35], s63 offen lds
    s_add_u32 m0, s72, 154880
    s_add_u32 s63, s72, 16384
    buffer_load_dwordx4 v7, s[32:35], s63 offen lds
L_nostage:
    s_mov_b32 s28, s6
    s_mov_b32 s29, s7
    s_mov_b32 s30, 6400000
    s_mov_b32 s31, 0x20000
    s_mov_b32 s36, s10
    s_mov_b32 s37, s11
    s_mov_b32 s38, 819200
    s_mov_b32 s39, 0x20000
    s_mov_b32 s40, s18
    s_mov_b32 s41, s19
    s_mov_b32 s42, 8192
    s_mov_b32 s43, 0x20000
    s_mov_b32 s44, s12
    s_mov_b32 s45, s13
    s_mov_b32 s46, 256
    s_mov_b32 s47, 0x20000
    s_mov_b32 s48, s14
    s_mov_b32 s49, s15
    s_mov_b32 s50, 256
    s_mov_b32 s51, 0x20000
    s_mov_b32 s52, s16
    s_mov_b32 s53, s17
    s_mov_b32 s54, 4
    s_mov_b32 s55, 0x20000
    s_mov_b64 s[20:21], s[66:67]
    s_mov_b32 s12, s66
    s_mov_b32 s13, s67
    s_mov_b32 s14, 131072
    s_mov_b32 s15, 0x20000
    s_mov_b32 s16, s64
    s_mov_b32 s17, s65
    s_mov_b32 s18, 256
    s_mov_b32 s19, 0x20000
    s_lshl_b32 s63, s70, 7
    v_and_b32 v8, 7, v5
    v_lshlrev_b32 v8, 4, v8
    v_lshrrev_b32 v2, 3, v5
    v_lshl_add_u32 v8, v2, 3, v8
    v_lshl_add_u32 v8, v6, 1, v8
    v_add_u32 v8, s63, v8
    v_mov_b32 v11, 0
    s_cmp_ge_u32 s3, 4
    s_cbranch_scc1 L_M
    buffer_load_dword v12, v11, s[12:15], 0 offen offset:4
    buffer_load_ushort v56, v11, s[52:55], 0 offen
    buffer_load_ushort v13, v8, s[44:47], 0 offen
    buffer_load_ushort v14, v8, s[48:51], 0 offen
    v_lshrrev_b32 v2, 2, v1
    s_lshl_b32 s63, s70, 4
    v_add_u32 v3, s63, v2
    v_mul_u32_u24 v60, 400, v3
    s_lshl_b32 s64, s57, 4
    s_add_u32 s64, s64, 125696
    v_add_u32 v60, s64, v60
    v_subrev_u32 v3, s57, v2
    v_and_b32 v3, 3, v3
    v_and_b32 v4, 12, v2
    v_or_b32 v3, v3, v4
    v_add_u32 v3, s63, v3
    v_mul_u32_u24 v61, 400, v3
    s_lshl_b32 s64, s57, 2
    s_add_u32 s64, s64, 126080
    v_add_u32 v61, s64, v61
    s_add_u32 s63, s73, 0
    s_cmp_ge_u32 s63, 6
    s_cselect_b32 s68, 6, 0
    s_sub_u32 s63, s63, s68
    s_lshl_b32 s63, s63, 6
    v_add_u32 v64, s63, v60
    s_add_u32 s63, s73, 1
    s_cmp_ge_u32 s63, 6
    s_cselect_b32 s68, 6, 0
    s_sub_u32 s63, s63, s68
    s_lshl_b32 s63, s63, 6
    v_add_u32 v65, s63, v60
    s_add_u32 s63, s73, 2
    s_cmp_ge_u32 s63, 6
    s_cselect_b32 s68, 6, 0
    s_sub_u32 s63, s63, s68
    s_lshl_b32 s63, s63, 6
    v_add_u32 v66, s63, v60
    s_add_u32 s63, s73, 3
    s_cmp_ge_u32 s63, 6
    s_cselect_b32 s68, 6, 0
    s_sub_u32 s63, s63, s68
    s_lshl_b32 s63, s63, 6
    v_add_u32 v67, s63, v60
    s_add_u32 s63, s73, 4
    s_cmp_ge_u32 s63, 6
    s_cselect_b32 s68, 6, 0
    s_sub_u32 s63, s63, s68
    s_lshl_b32 s63, s63, 6
    v_add_u32 v68, s63, v60
    s_add_u32 s63, s73, 5
    s_cmp_ge_u32 s63, 6
    s_cselect_b32 s68, 6, 0
    s_sub_u32 s63, s63, s68
    s_lshl_b32 s63, s63, 6
    v_add_u32 v69, s63, v60
    v_and_b32 v3, 3, v1
    v_lshrrev_b32 v4, 5, v1
    v_lshlrev_b32 v4, 1, v4
    v_xor_b32 v10, v3, v4
    v_lshlrev_b32 v10, 4, v10
    s_lshr_b32 s63, s57, 1
    s_lshl_b32 s63, s63, 5
    v_xor_b32 v9, s63, v10
    s_lshl_b32 s4, s57, 12
    s_lshl_b32 s5, s57, 10
    s_waitcnt vmcnt(12)
    s_add_u32 m0, s4, 0
    v_lshl_add_u32 v2, v176, 6, v9
    buffer_load_dwordx4 v2, s[28:31], 0 offen  lds
    v_mov_b32_dpp v2, v177 row_ror:4 row_mask:0xf bank_mask:0xf
    s_add_u32 m0, s4, 1024
    v_lshl_add_u32 v2, v2, 6, v9
    buffer_load_dwordx4 v2, s[28:31], 0 offen  lds
    v_mov_b32_dpp v2, v178 row_ror:8 row_mask:0xf bank_mask:0xf
    s_add_u32 m0, s4, 2048
    v_lshl_add_u32 v2, v2, 6, v9
    buffer_load_dwordx4 v2, s[28:31], 0 offen  lds
    v_mov_b32_dpp v2, v179 row_ror:12 row_mask:0xf bank_mask:0xf
    s_add_u32 m0, s4, 3072
    v_lshl_add_u32 v2, v2, 6, v9
    buffer_load_dwordx4 v2, s[28:31], 0 offen  lds
    s_setprio 0
    v_mul_u32_u24 v63, 200, v5
    v_lshl_add_u32 v63, v6, 3, v63
    v_add_u32 v63, 138496, v63
    s_lshl_b32 s74, s57, 2
    s_lshl_b32 s63, s57, 10
    s_add_u32 s63, s63, 102400
    v_lshrrev_b32 v50, 2, v5
    v_lshlrev_b32 v50, 8, v50
    v_lshl_add_u32 v50, v6, 6, v50
    v_and_b32 v62, 3, v5
    v_lshl_add_u32 v50, v62, 2, v50
    v_add_u32 v50, s63, v50
    v_lshlrev_b32 v62, 4, v1
    v_add_u32 v62, s63, v62
    v_lshrrev_b32 v2, 3, v5
    s_lshr_b32 s63, s57, 1
    v_xor_b32 v2, s63, v2
    v_and_b32 v2, 1, v2
    v_lshlrev_b32 v2, 1, v2
    v_xor_b32 v2, v2, v6
    v_lshlrev_b32 v2, 4, v2
    v_lshl_add_u32 v2, v5, 10, v2
    s_lshl_b32 s63, s57, 8
    v_add_u32 v2, s63, v2
    v_add_u32 v3, 0, v5
    v_and_b32 v3, 3, v3
    v_lshl_add_u32 v16, v3, 6, v2
    v_add_u32 v21, 65536, v16
    v_add_u32 v3, 1, v5
    v_and_b32 v3, 3, v3
    v_lshl_add_u32 v17, v3, 6, v2
    v_add_u32 v22, 65536, v17
    v_add_u32 v3, 2, v5
    v_and_b32 v3, 3, v3
    v_lshl_add_u32 v18, v3, 6, v2
    v_add_u32 v23, 65536, v18
    v_add_u32 v3, 3, v5
    v_and_b32 v3, 3, v3
    v_lshl_add_u32 v19, v3, 6, v2
    v_add_u32 v24, 65536, v19
    s_lshr_b32 s63, s57, 1
    s_lshl_b32 s63, s63, 1
    v_xor_b32 v2, s63, v6
    v_lshlrev_b32 v2, 4, v2
    v_lshrrev_b32 v4, 2, v5
    v_lshl_add_u32 v2, v4, 10, v2
    s_lshl_b32 s63, s57, 8
    s_add_u32 s63, s63, 98304
    v_add_u32 v2, s63, v2
    v_add_u32 v3, 0, v4
    v_and_b32 v3, 3, v3
    v_lshl_add_u32 v25, v3, 6, v2
    v_add_u32 v3, 1, v4
    v_and_b32 v3, 3, v3
    v_lshl_add_u32 v26, v3, 6, v2
    v_add_u32 v3, 2, v4
    v_and_b32 v3, 3, v3
    v_lshl_add_u32 v27, v3, 6, v2
    v_add_u32 v3, 3, v4
    v_and_b32 v3, 3, v3
    v_lshl_add_u32 v28, v3, 6, v2
    v_lshlrev_b32 v30, 4, v1
    v_add_u32 v30, 102400, v30
    v_lshlrev_b32 v31, 2, v1
    v_add_u32 v31, 123904, v31
    v_mov_b32 v52, 0
    v_mov_b32 v53, 0
    v_mov_b32 v54, 0
    v_mov_b32 v55, 0
    s_waitcnt vmcnt(0)
    s_barrier
    ds_read_b128 v[180:183], v65
    ds_read_b128 v[184:187], v66
    ds_read_b128 v[188:191], v67
    ds_read_b128 v[192:195], v68
    ds_read_b128 v[196:199], v69
    ds_read_b32 v200, v61
    s_waitcnt lgkmcnt(5)
    s_setprio 2
    s_add_u32 m0, s4, 16384
    v_lshl_add_u32 v2, v180, 6, v9
    buffer_load_dwordx4 v2, s[28:31], 0 offen  lds
    v_mov_b32_dpp v2, v181 row_ror:4 row_mask:0xf bank_mask:0xf
    s_add_u32 m0, s4, 17408
    v_lshl_add_u32 v2, v2, 6, v9
    buffer_load_dwordx4 v2, s[28:31], 0 offen  lds
    v_mov_b32_dpp v2, v182 row_ror:8 row_mask:0xf bank_mask:0xf
    s_add_u32 m0, s4, 18432
    v_lshl_add_u32 v2, v2, 6, v9
    buffer_load_dwordx4 v2, s[28:31], 0 offen  lds
    v_mov_b32_dpp v2, v183 row_ror:12 row_mask:0xf bank_mask:0xf
    s_add_u32 m0, s4, 19456
    v_lshl_add_u32 v2, v2, 6, v9
    buffer_load_dwordx4 v2, s[28:31], 0 offen  lds
    s_setprio 0
    s_waitcnt lgkmcnt(0)
    ds_read_b128 v[64:67], v16
    ds_read_b128 v[92:95], v17
    ds_read_b128 v[120:123], v18
    ds_read_b128 v[148:151], v19
    v_add_u32 v12, 1, v12
    v_or_b32 v12, 0x80000000, v12
    s_or_b32 s63, s2, s3
    s_cmp_lg_u32 s63, 0
    s_cbranch_scc1 L_nopub
    v_mov_b32 v58, v12
    v_mov_b32 v59, 0
    s_mov_b64 exec, 1
    buffer_atomic_cmpswap v[58:59], v11, s[16:19], 0 offen sc1
    s_mov_b64 exec, -1
L_nopub:
    s_waitcnt lgkmcnt(0)
    v_mov_b32 v88, 0
    v_mov_b32 v89, 0
    v_mov_b32 v90, 0
    v_mov_b32 v91, 0
    v_mov_b32 v116, 0
    v_mov_b32 v117, 0
    v_mov_b32 v118, 0
    v_mov_b32 v119, 0
    v_mov_b32 v144, 0
    v_mov_b32 v145, 0
    v_mov_b32 v146, 0
    v_mov_b32 v147, 0
    v_mov_b32 v172, 0
    v_mov_b32 v173, 0
    v_mov_b32 v174, 0
    v_mov_b32 v175, 0
    s_lshr_b32 s64, 8464, s74
    s_and_b32 s64, s64, 15
    s_lshr_b32 s65, 256, s74
    s_and_b32 s65, s65, 15
    s_cmp_eq_u32 s64, s65
    s_cselect_b32 s72, 0, -1
    s_add_u32 s64, s64, s73
    s_cmp_ge_u32 s64, 6
    s_cselect_b32 s66, 6, 0
    s_sub_u32 s64, s64, s66
    s_add_u32 s65, s65, s73
    s_cmp_ge_u32 s65, 6
    s_cselect_b32 s66, 6, 0
    s_sub_u32 s65, s65, s66
    s_mul_i32 s66, s64, 3200
    s_lshl_b32 s67, s65, 5
    s_add_u32 s66, s66, s67
    s_mul_i32 s67, s65, 3200
    s_lshl_b32 s68, s64, 5
    s_add_u32 s67, s67, s68
    v_add_u32 v248, s66, v63
    v_add_u32 v249, s67, v63
    ds_read_b64 v[244:245], v248
    ds_read_b64 v[246:247], v249
    s_waitcnt lgkmcnt(1)
    v_and_b32 v244, s72, v244
    v_and_b32 v245, s72, v245
    v_lshlrev_b32 v248, 16, v244
    v_and_b32 v249, s62, v244
    v_lshlrev_b32 v250, 16, v245
    v_and_b32 v251, s62, v245
    ds_write_b32 v50, v248 offset:0
    ds_write_b32 v50, v249 offset:16
    ds_write_b32 v50, v250 offset:32
    ds_write_b32 v50, v251 offset:48
    ds_read_b128 v[248:251], v62 offset:0
    s_waitcnt lgkmcnt(5)
    v_lshlrev_b32 v252, 16, v246
    v_and_b32 v253, s62, v246
    v_lshlrev_b32 v254, 16, v247
    v_and_b32 v255, s62, v247
    s_waitcnt lgkmcnt(0)
    v_add_f32 v248, v248, v252
    v_add_f32 v249, v249, v253
    v_add_f32 v250, v250, v254
    v_add_f32 v251, v251, v255
    ds_write_b128 v62, v[248:251] offset:0
    s_lshr_b32 s64, 13090, s74
    s_and_b32 s64, s64, 15
    s_lshr_b32 s65, 4129, s74
    s_and_b32 s65, s65, 15
    s_cmp_eq_u32 s64, s65
    s_cselect_b32 s72, 0, -1
    s_add_u32 s64, s64, s73
    s_cmp_ge_u32 s64, 6
    s_cselect_b32 s66, 6, 0
    s_sub_u32 s64, s64, s66
    s_add_u32 s65, s65, s73
    s_cmp_ge_u32 s65, 6
    s_cselect_b32 s66, 6, 0
    s_sub_u32 s65, s65, s66
    s_mul_i32 s66, s64, 3200
    s_lshl_b32 s67, s65, 5
    s_add_u32 s66, s66, s67
    s_mul_i32 s67, s65, 3200
    s_lshl_b32 s68, s64, 5
    s_add_u32 s67, s67, s68
    v_add_u32 v248, s66, v63
    v_add_u32 v249, s67, v63
    ds_read_b64 v[244:245], v248
    ds_read_b64 v[246:247], v249
    s_waitcnt lgkmcnt(1)
    v_and_b32 v244, s72, v244
    v_and_b32 v245, s72, v245
    v_lshlrev_b32 v248, 16, v244
    v_and_b32 v249, s62, v244
    v_lshlrev_b32 v250, 16, v245
    v_and_b32 v251, s62, v245
    ds_write_b32 v50, v248 offset:4096
    ds_write_b32 v50, v249 offset:4112
    ds_write_b32 v50, v250 offset:4128
    ds_write_b32 v50, v251 offset:4144
    ds_read_b128 v[248:251], v62 offset:4096
    s_waitcnt lgkmcnt(5)
    v_lshlrev_b32 v252, 16, v246
    v_and_b32 v253, s62, v246
    v_lshlrev_b32 v254, 16, v247
    v_and_b32 v255, s62, v247
    s_waitcnt lgkmcnt(0)
    v_add_f32 v248, v248, v252
    v_add_f32 v249, v249, v253
    v_add_f32 v250, v250, v254
    v_add_f32 v251, v251, v255
    ds_write_b128 v62, v[248:251] offset:4096
    s_waitcnt lgkmcnt(0)
    s_waitcnt vmcnt(0)
    s_barrier
    s_setprio 2
    s_add_u32 m0, s4, 32768
    v_lshl_add_u32 v2, v184, 6, v9
    buffer_load_dwordx4 v2, s[28:31], 0 offen  lds
    v_mov_b32_dpp v2, v185 row_ror:4 row_mask:0xf bank_mask:0xf
    s_add_u32 m0, s4, 33792
    v_lshl_add_u32 v2, v2, 6, v9
    buffer_load_dwordx4 v2, s[28:31], 0 offen  lds
    v_mov_b32_dpp v2, v186 row_ror:8 row_mask:0xf bank_mask:0xf
    s_add_u32 m0, s4, 34816
    v_lshl_add_u32 v2, v2, 6, v9
    buffer_load_dwordx4 v2, s[28:31], 0 offen  lds
    v_mov_b32_dpp v2, v187 row_ror:12 row_mask:0xf bank_mask:0xf
    s_add_u32 m0, s4, 35840
    v_lshl_add_u32 v2, v2, 6, v9
    buffer_load_dwordx4 v2, s[28:31], 0 offen  lds
    s_setprio 0
    ds_read_b128 v[68:71], v16 offset:16384
    ds_read_b128 v[96:99], v17 offset:16384
    ds_read_b128 v[124:127], v18 offset:16384
    ds_read_b128 v[152:155], v19 offset:16384
    ds_read_b128 v[204:207], v30 offset:0
    ds_read_b128 v[208:211], v30 offset:1024
    ds_read_b128 v[212:215], v30 offset:2048
    s_waitcnt lgkmcnt(2)
    v_mfma_f32_16x16x32_bf16 v[228:231], v[64:67], v[64:67], 0
    v_mfma_f32_16x16x32_bf16 v[232:235], v[92:95], v[92:95], 0
    v_mfma_f32_16x16x32_bf16 v[236:239], v[120:123], v[120:123], 0
    v_mfma_f32_16x16x32_bf16 v[240:243], v[148:151], v[148:151], 0
    s_waitcnt lgkmcnt(1)
    v_mfma_f32_16x16x32_bf16 v[32:35], v[68:71], v[64:67], 0
    v_mfma_f32_16x16x32_bf16 v[36:39], v[96:99], v[92:95], 0
    v_mfma_f32_16x16x32_bf16 v[40:43], v[124:127], v[120:123], 0
    v_mfma_f32_16x16x32_bf16 v[44:47], v[152:155], v[148:151], 0
    s_nop 2
    v_fmac_f32 v52, v204, v228
    v_fmac_f32 v53, v204, v232
    v_fmac_f32 v54, v204, v236
    v_fmac_f32 v55, v204, v240
    v_fmac_f32 v52, v205, v229
    v_fmac_f32 v53, v205, v233
    v_fmac_f32 v54, v205, v237
    v_fmac_f32 v55, v205, v241
    v_fmac_f32 v52, v206, v230
    v_fmac_f32 v53, v206, v234
    v_fmac_f32 v54, v206, v238
    v_fmac_f32 v55, v206, v242
    v_fmac_f32 v52, v207, v231
    v_fmac_f32 v53, v207, v235
    v_fmac_f32 v54, v207, v239
    v_fmac_f32 v55, v207, v243
    s_waitcnt lgkmcnt(0)
    v_mfma_f32_16x16x32_bf16 v[228:231], v[68:71], v[68:71], 0
    v_mfma_f32_16x16x32_bf16 v[232:235], v[96:99], v[96:99], 0
    v_mfma_f32_16x16x32_bf16 v[236:239], v[124:127], v[124:127], 0
    v_mfma_f32_16x16x32_bf16 v[240:243], v[152:155], v[152:155], 0
    v_fmac_f32 v52, v208, v32
    v_fmac_f32 v53, v208, v36
    v_fmac_f32 v54, v208, v40
    v_fmac_f32 v55, v208, v44
    v_fmac_f32 v52, v209, v33
    v_fmac_f32 v53, v209, v37
    v_fmac_f32 v54, v209, v41
    v_fmac_f32 v55, v209, v45
    v_fmac_f32 v52, v210, v34
    v_fmac_f32 v53, v210, v38
    v_fmac_f32 v54, v210, v42
    v_fmac_f32 v55, v210, v46
    v_fmac_f32 v52, v211, v35
    v_fmac_f32 v53, v211, v39
    v_fmac_f32 v54, v211, v43
    v_fmac_f32 v55, v211, v47
    s_lshr_b32 s64, 17459, s74
    s_and_b32 s64, s64, 15
    s_lshr_b32 s65, 4146, s74
    s_and_b32 s65, s65, 15
    s_cmp_eq_u32 s64, s65
    s_cselect_b32 s72, 0, -1
    s_add_u32 s64, s64, s73
    s_cmp_ge_u32 s64, 6
    s_cselect_b32 s66, 6, 0
    s_sub_u32 s64, s64, s66
    s_add_u32 s65, s65, s73
    s_cmp_ge_u32 s65, 6
    s_cselect_b32 s66, 6, 0
    s_sub_u32 s65, s65, s66
    s_mul_i32 s66, s64, 3200
    s_lshl_b32 s67, s65, 5
    s_add_u32 s66, s66, s67
    s_mul_i32 s67, s65, 3200
    s_lshl_b32 s68, s64, 5
    s_add_u32 s67, s67, s68
    v_add_u32 v248, s66, v63
    v_add_u32 v249, s67, v63
    ds_read_b64 v[244:245], v248
    ds_read_b64 v[246:247], v249
    s_waitcnt lgkmcnt(1)
    v_and_b32 v244, s72, v244
    v_and_b32 v245, s72, v245
    v_lshlrev_b32 v248, 16, v244
    v_and_b32 v249, s62, v244
    v_lshlrev_b32 v250, 16, v245
    v_and_b32 v251, s62, v245
    ds_write_b32 v50, v248 offset:8192
    ds_write_b32 v50, v249 offset:8208
    ds_write_b32 v50, v250 offset:8224
    ds_write_b32 v50, v251 offset:8240
    ds_read_b128 v[248:251], v62 offset:8192
    s_waitcnt lgkmcnt(5)
    v_lshlrev_b32 v252, 16, v246
    v_and_b32 v253, s62, v246
    v_lshlrev_b32 v254, 16, v247
    v_and_b32 v255, s62, v247
    s_waitcnt lgkmcnt(0)
    v_add_f32 v248, v248, v252
    v_add_f32 v249, v249, v253
    v_add_f32 v250, v250, v254
    v_add_f32 v251, v251, v255
    ds_write_b128 v62, v[248:251] offset:8192
    s_waitcnt lgkmcnt(0)
    s_nop 3
    s_waitcnt vmcnt(0)
    s_barrier
    s_setprio 2
    s_add_u32 m0, s4, 49152
    v_lshl_add_u32 v2, v188, 6, v9
    buffer_load_dwordx4 v2, s[28:31], 0 offen  lds
    v_mov_b32_dpp v2, v189 row_ror:4 row_mask:0xf bank_mask:0xf
    s_add_u32 m0, s4, 50176
    v_lshl_add_u32 v2, v2, 6, v9
    buffer_load_dwordx4 v2, s[28:31], 0 offen  lds
    v_mov_b32_dpp v2, v190 row_ror:8 row_mask:0xf bank_mask:0xf
    s_add_u32 m0, s4, 51200
    v_lshl_add_u32 v2, v2, 6, v9
    buffer_load_dwordx4 v2, s[28:31], 0 offen  lds
    v_mov_b32_dpp v2, v191 row_ror:12 row_mask:0xf bank_mask:0xf
    s_add_u32 m0, s4, 52224
    v_lshl_add_u32 v2, v2, 6, v9
    buffer_load_dwordx4 v2, s[28:31], 0 offen  lds
    s_setprio 0
    ds_read_b128 v[72:75], v16 offset:32768
    ds_read_b128 v[100:103], v17 offset:32768
    ds_read_b128 v[128:131], v18 offset:32768
    ds_read_b128 v[156:159], v19 offset:32768
    v_fmac_f32 v52, v212, v228
    v_fmac_f32 v53, v212, v232
    v_fmac_f32 v54, v212, v236
    v_fmac_f32 v55, v212, v240
    v_fmac_f32 v52, v213, v229
    v_fmac_f32 v53, v213, v233
    v_fmac_f32 v54, v213, v237
    v_fmac_f32 v55, v213, v241
    v_fmac_f32 v52, v214, v230
    v_fmac_f32 v53, v214, v234
    v_fmac_f32 v54, v214, v238
    v_fmac_f32 v55, v214, v242
    v_fmac_f32 v52, v215, v231
    v_fmac_f32 v53, v215, v235
    v_fmac_f32 v54, v215, v239
    v_fmac_f32 v55, v215, v243
    ds_read_b128 v[204:207], v30 offset:3072
    ds_read_b128 v[208:211], v30 offset:4096
    ds_read_b128 v[212:215], v30 offset:5120
    s_waitcnt lgkmcnt(2)
    v_mfma_f32_16x16x32_bf16 v[32:35], v[72:75], v[64:67], 0
    v_mfma_f32_16x16x32_bf16 v[36:39], v[100:103], v[92:95], 0
    v_mfma_f32_16x16x32_bf16 v[40:43], v[128:131], v[120:123], 0
    v_mfma_f32_16x16x32_bf16 v[44:47], v[156:159], v[148:151], 0
    s_waitcnt lgkmcnt(1)
    v_mfma_f32_16x16x32_bf16 v[228:231], v[72:75], v[68:71], 0
    v_mfma_f32_16x16x32_bf16 v[232:235], v[100:103], v[96:99], 0
    v_mfma_f32_16x16x32_bf16 v[236:239], v[128:131], v[124:127], 0
    v_mfma_f32_16x16x32_bf16 v[240:243], v[156:159], v[152:155], 0
    s_nop 2
    v_fmac_f32 v52, v204, v32
    v_fmac_f32 v53, v204, v36
    v_fmac_f32 v54, v204, v40
    v_fmac_f32 v55, v204, v44
    v_fmac_f32 v52, v205, v33
    v_fmac_f32 v53, v205, v37
    v_fmac_f32 v54, v205, v41
    v_fmac_f32 v55, v205, v45
    v_fmac_f32 v52, v206, v34
    v_fmac_f32 v53, v206, v38
    v_fmac_f32 v54, v206, v42
    v_fmac_f32 v55, v206, v46
    v_fmac_f32 v52, v207, v35
    v_fmac_f32 v53, v207, v39
    v_fmac_f32 v54, v207, v43
    v_fmac_f32 v55, v207, v47
    s_waitcnt lgkmcnt(0)
    v_mfma_f32_16x16x32_bf16 v[32:35], v[72:75], v[72:75], 0
    v_mfma_f32_16x16x32_bf16 v[36:39], v[100:103], v[100:103], 0
    v_mfma_f32_16x16x32_bf16 v[40:43], v[128:131], v[128:131], 0
    v_mfma_f32_16x16x32_bf16 v[44:47], v[156:159], v[156:159], 0
    v_fmac_f32 v52, v208, v228
    v_fmac_f32 v53, v208, v232
    v_fmac_f32 v54, v208, v236
    v_fmac_f32 v55, v208, v240
    v_fmac_f32 v52, v209, v229
    v_fmac_f32 v53, v209, v233
    v_fmac_f32 v54, v209, v237
    v_fmac_f32 v55, v209, v241
    v_fmac_f32 v52, v210, v230
    v_fmac_f32 v53, v210, v234
    v_fmac_f32 v54, v210, v238
    v_fmac_f32 v55, v210, v242
    v_fmac_f32 v52, v211, v231
    v_fmac_f32 v53, v211, v235
    v_fmac_f32 v54, v211, v239
    v_fmac_f32 v55, v211, v243
    s_lshr_b32 s64, 21572, s74
    s_and_b32 s64, s64, 15
    s_lshr_b32 s65, 1074, s74
    s_and_b32 s65, s65, 15
    s_cmp_eq_u32 s64, s65
    s_cselect_b32 s72, 0, -1
    s_add_u32 s64, s64, s73
    s_cmp_ge_u32 s64, 6
    s_cselect_b32 s66, 6, 0
    s_sub_u32 s64, s64, s66
    s_add_u32 s65, s65, s73
    s_cmp_ge_u32 s65, 6
    s_cselect_b32 s66, 6, 0
    s_sub_u32 s65, s65, s66
    s_mul_i32 s66, s64, 3200
    s_lshl_b32 s67, s65, 5
    s_add_u32 s66, s66, s67
    s_mul_i32 s67, s65, 3200
    s_lshl_b32 s68, s64, 5
    s_add_u32 s67, s67, s68
    v_add_u32 v248, s66, v63
    v_add_u32 v249, s67, v63
    ds_read_b64 v[244:245], v248
    ds_read_b64 v[246:247], v249
    s_waitcnt lgkmcnt(1)
    v_and_b32 v244, s72, v244
    v_and_b32 v245, s72, v245
    v_lshlrev_b32 v248, 16, v244
    v_and_b32 v249, s62, v244
    v_lshlrev_b32 v250, 16, v245
    v_and_b32 v251, s62, v245
    ds_write_b32 v50, v248 offset:12288
    ds_write_b32 v50, v249 offset:12304
    ds_write_b32 v50, v250 offset:12320
    ds_write_b32 v50, v251 offset:12336
    ds_read_b128 v[248:251], v62 offset:12288
    s_waitcnt lgkmcnt(5)
    v_lshlrev_b32 v252, 16, v246
    v_and_b32 v253, s62, v246
    v_lshlrev_b32 v254, 16, v247
    v_and_b32 v255, s62, v247
    s_waitcnt lgkmcnt(0)
    v_add_f32 v248, v248, v252
    v_add_f32 v249, v249, v253
    v_add_f32 v250, v250, v254
    v_add_f32 v251, v251, v255
    ds_write_b128 v62, v[248:251] offset:12288
    s_waitcnt lgkmcnt(0)
    s_nop 3
    s_waitcnt vmcnt(0)
    s_barrier
    s_setprio 2
    s_add_u32 m0, s4, 65536
    v_lshl_add_u32 v2, v192, 6, v9
    buffer_load_dwordx4 v2, s[28:31], 0 offen  lds
    v_mov_b32_dpp v2, v193 row_ror:4 row_mask:0xf bank_mask:0xf
    s_add_u32 m0, s4, 66560
    v_lshl_add_u32 v2, v2, 6, v9
    buffer_load_dwordx4 v2, s[28:31], 0 offen  lds
    v_mov_b32_dpp v2, v194 row_ror:8 row_mask:0xf bank_mask:0xf
    s_add_u32 m0, s4, 67584
    v_lshl_add_u32 v2, v2, 6, v9
    buffer_load_dwordx4 v2, s[28:31], 0 offen  lds
    v_mov_b32_dpp v2, v195 row_ror:12 row_mask:0xf bank_mask:0xf
    s_add_u32 m0, s4, 68608
    v_lshl_add_u32 v2, v2, 6, v9
    buffer_load_dwordx4 v2, s[28:31], 0 offen  lds
    s_setprio 0
    ds_read_b128 v[76:79], v16 offset:49152
    ds_read_b128 v[104:107], v17 offset:49152
    ds_read_b128 v[132:135], v18 offset:49152
    ds_read_b128 v[160:163], v19 offset:49152
    v_fmac_f32 v52, v212, v32
    v_fmac_f32 v53, v212, v36
    v_fmac_f32 v54, v212, v40
    v_fmac_f32 v55, v212, v44
    v_fmac_f32 v52, v213, v33
    v_fmac_f32 v53, v213, v37
    v_fmac_f32 v54, v213, v41
    v_fmac_f32 v55, v213, v45
    v_fmac_f32 v52, v214, v34
    v_fmac_f32 v53, v214, v38
    v_fmac_f32 v54, v214, v42
    v_fmac_f32 v55, v214, v46
    v_fmac_f32 v52, v215, v35
    v_fmac_f32 v53, v215, v39
    v_fmac_f32 v54, v215, v43
    v_fmac_f32 v55, v215, v47
    ds_read_b128 v[204:207], v30 offset:6144
    ds_read_b128 v[208:211], v30 offset:7168
    ds_read_b128 v[212:215], v30 offset:8192
    ds_read_b128 v[216:219], v30 offset:9216
    s_waitcnt lgkmcnt(3)
    v_mfma_f32_16x16x32_bf16 v[228:231], v[76:79], v[64:67], 0
    v_mfma_f32_16x16x32_bf16 v[232:235], v[104:107], v[92:95], 0
    v_mfma_f32_16x16x32_bf16 v[236:239], v[132:135], v[120:123], 0
    v_mfma_f32_16x16x32_bf16 v[240:243], v[160:163], v[148:151], 0
    s_waitcnt lgkmcnt(2)
    v_mfma_f32_16x16x32_bf16 v[32:35], v[76:79], v[68:71], 0
    v_mfma_f32_16x16x32_bf16 v[36:39], v[104:107], v[96:99], 0
    v_mfma_f32_16x16x32_bf16 v[40:43], v[132:135], v[124:127], 0
    v_mfma_f32_16x16x32_bf16 v[44:47], v[160:163], v[152:155], 0
    s_nop 2
    v_fmac_f32 v52, v204, v228
    v_fmac_f32 v53, v204, v232
    v_fmac_f32 v54, v204, v236
    v_fmac_f32 v55, v204, v240
    v_fmac_f32 v52, v205, v229
    v_fmac_f32 v53, v205, v233
    v_fmac_f32 v54, v205, v237
    v_fmac_f32 v55, v205, v241
    v_fmac_f32 v52, v206, v230
    v_fmac_f32 v53, v206, v234
    v_fmac_f32 v54, v206, v238
    v_fmac_f32 v55, v206, v242
    v_fmac_f32 v52, v207, v231
    v_fmac_f32 v53, v207, v235
    v_fmac_f32 v54, v207, v239
    v_fmac_f32 v55, v207, v243
    s_waitcnt lgkmcnt(1)
    v_mfma_f32_16x16x32_bf16 v[228:231], v[76:79], v[72:75], 0
    v_mfma_f32_16x16x32_bf16 v[232:235], v[104:107], v[100:103], 0
    v_mfma_f32_16x16x32_bf16 v[236:239], v[132:135], v[128:131], 0
    v_mfma_f32_16x16x32_bf16 v[240:243], v[160:163], v[156:159], 0
    v_fmac_f32 v52, v208, v32
    v_fmac_f32 v53, v208, v36
    v_fmac_f32 v54, v208, v40
    v_fmac_f32 v55, v208, v44
    v_fmac_f32 v52, v209, v33
    v_fmac_f32 v53, v209, v37
    v_fmac_f32 v54, v209, v41
    v_fmac_f32 v55, v209, v45
    v_fmac_f32 v52, v210, v34
    v_fmac_f32 v53, v210, v38
    v_fmac_f32 v54, v210, v42
    v_fmac_f32 v55, v210, v46
    v_fmac_f32 v52, v211, v35
    v_fmac_f32 v53, v211, v39
    v_fmac_f32 v54, v211, v43
    v_fmac_f32 v55, v211, v47
    s_waitcnt lgkmcnt(0)
    v_mfma_f32_16x16x32_bf16 v[32:35], v[76:79], v[76:79], 0
    v_mfma_f32_16x16x32_bf16 v[36:39], v[104:107], v[104:107], 0
    v_mfma_f32_16x16x32_bf16 v[40:43], v[132:135], v[132:135], 0
    v_mfma_f32_16x16x32_bf16 v[44:47], v[160:163], v[160:163], 0
    v_fmac_f32 v52, v212, v228
    v_fmac_f32 v53, v212, v232
    v_fmac_f32 v54, v212, v236
    v_fmac_f32 v55, v212, v240
    v_fmac_f32 v52, v213, v229
    v_fmac_f32 v53, v213, v233
    v_fmac_f32 v54, v213, v237
    v_fmac_f32 v55, v213, v241
    v_fmac_f32 v52, v214, v230
    v_fmac_f32 v53, v214, v234
    v_fmac_f32 v54, v214, v238
    v_fmac_f32 v55, v214, v242
    v_fmac_f32 v52, v215, v231
    v_fmac_f32 v53, v215, v235
    v_fmac_f32 v54, v215, v239
    v_fmac_f32 v55, v215, v243
    s_lshr_b32 s64, 21845, s74
    s_and_b32 s64, s64, 15
    s_lshr_b32 s65, 17185, s74
    s_and_b32 s65, s65, 15
    s_cmp_eq_u32 s64, s65
    s_cselect_b32 s72, 0, -1
    s_add_u32 s64, s64, s73
    s_cmp_ge_u32 s64, 6
    s_cselect_b32 s66, 6, 0
    s_sub_u32 s64, s64, s66
    s_add_u32 s65, s65, s73
    s_cmp_ge_u32 s65, 6
    s_cselect_b32 s66, 6, 0
    s_sub_u32 s65, s65, s66
    s_mul_i32 s66, s64, 3200
    s_lshl_b32 s67, s65, 5
    s_add_u32 s66, s66, s67
    s_mul_i32 s67, s65, 3200
    s_lshl_b32 s68, s64, 5
    s_add_u32 s67, s67, s68
    v_add_u32 v248, s66, v63
    v_add_u32 v249, s67, v63
    ds_read_b64 v[244:245], v248
    ds_read_b64 v[246:247], v249
    s_waitcnt lgkmcnt(1)
    v_and_b32 v244, s72, v244
    v_and_b32 v245, s72, v245
    v_lshlrev_b32 v248, 16, v244
    v_and_b32 v249, s62, v244
    v_lshlrev_b32 v250, 16, v245
    v_and_b32 v251, s62, v245
    ds_write_b32 v50, v248 offset:16384
    ds_write_b32 v50, v249 offset:16400
    ds_write_b32 v50, v250 offset:16416
    ds_write_b32 v50, v251 offset:16432
    ds_read_b128 v[248:251], v62 offset:16384
    s_waitcnt lgkmcnt(5)
    v_lshlrev_b32 v252, 16, v246
    v_and_b32 v253, s62, v246
    v_lshlrev_b32 v254, 16, v247
    v_and_b32 v255, s62, v247
    s_waitcnt lgkmcnt(0)
    v_add_f32 v248, v248, v252
    v_add_f32 v249, v249, v253
    v_add_f32 v250, v250, v254
    v_add_f32 v251, v251, v255
    ds_write_b128 v62, v[248:251] offset:16384
    s_cmp_lg_u32 s57, 0
    s_cbranch_scc1 L_bsk5
    s_lshr_b32 s64, 21845, s74
    s_and_b32 s64, s64, 15
    s_lshr_b32 s65, 21845, s74
    s_and_b32 s65, s65, 15
    s_cmp_eq_u32 s64, s65
    s_cselect_b32 s72, 0, -1
    s_add_u32 s64, s64, s73
    s_cmp_ge_u32 s64, 6
    s_cselect_b32 s66, 6, 0
    s_sub_u32 s64, s64, s66
    s_add_u32 s65, s65, s73
    s_cmp_ge_u32 s65, 6
    s_cselect_b32 s66, 6, 0
    s_sub_u32 s65, s65, s66
    s_mul_i32 s66, s64, 3200
    s_lshl_b32 s67, s65, 5
    s_add_u32 s66, s66, s67
    s_mul_i32 s67, s65, 3200
    s_lshl_b32 s68, s64, 5
    s_add_u32 s67, s67, s68
    v_add_u32 v248, s66, v63
    v_add_u32 v249, s67, v63
    ds_read_b64 v[244:245], v248
    ds_read_b64 v[246:247], v249
    s_waitcnt lgkmcnt(1)
    v_and_b32 v244, s72, v244
    v_and_b32 v245, s72, v245
    v_lshlrev_b32 v248, 16, v244
    v_and_b32 v249, s62, v244
    v_lshlrev_b32 v250, 16, v245
    v_and_b32 v251, s62, v245
    ds_write_b32 v50, v248 offset:20480
    ds_write_b32 v50, v249 offset:20496
    ds_write_b32 v50, v250 offset:20512
    ds_write_b32 v50, v251 offset:20528
    ds_read_b128 v[248:251], v62 offset:20480
    s_waitcnt lgkmcnt(5)
    v_lshlrev_b32 v252, 16, v246
    v_and_b32 v253, s62, v246
    v_lshlrev_b32 v254, 16, v247
    v_and_b32 v255, s62, v247
    s_waitcnt lgkmcnt(0)
    v_add_f32 v248, v248, v252
    v_add_f32 v249, v249, v253
    v_add_f32 v250, v250, v254
    v_add_f32 v251, v251, v255
    ds_write_b128 v62, v[248:251] offset:20480
L_bsk5:
    s_waitcnt lgkmcnt(0)
    s_nop 3
    s_waitcnt vmcnt(0)
    s_barrier
    s_setprio 2
    s_add_u32 m0, s4, 81920
    v_lshl_add_u32 v2, v196, 6, v9
    buffer_load_dwordx4 v2, s[28:31], 0 offen  lds
    v_mov_b32_dpp v2, v197 row_ror:4 row_mask:0xf bank_mask:0xf
    s_add_u32 m0, s4, 82944
    v_lshl_add_u32 v2, v2, 6, v9
    buffer_load_dwordx4 v2, s[28:31], 0 offen  lds
    v_mov_b32_dpp v2, v198 row_ror:8 row_mask:0xf bank_mask:0xf
    s_add_u32 m0, s4, 83968
    v_lshl_add_u32 v2, v2, 6, v9
    buffer_load_dwordx4 v2, s[28:31], 0 offen  lds
    v_mov_b32_dpp v2, v199 row_ror:12 row_mask:0xf bank_mask:0xf
    s_add_u32 m0, s4, 84992
    v_lshl_add_u32 v2, v2, 6, v9
    buffer_load_dwordx4 v2, s[28:31], 0 offen  lds
    s_setprio 0
    ds_read_b128 v[80:83], v21 offset:0
    ds_read_b128 v[108:111], v22 offset:0
    ds_read_b128 v[136:139], v23 offset:0
    ds_read_b128 v[164:167], v24 offset:0
    v_fmac_f32 v52, v216, v32
    v_fmac_f32 v53, v216, v36
    v_fmac_f32 v54, v216, v40
    v_fmac_f32 v55, v216, v44
    v_fmac_f32 v52, v217, v33
    v_fmac_f32 v53, v217, v37
    v_fmac_f32 v54, v217, v41
    v_fmac_f32 v55, v217, v45
    v_fmac_f32 v52, v218, v34
    v_fmac_f32 v53, v218, v38
    v_fmac_f32 v54, v218, v42
    v_fmac_f32 v55, v218, v46
    v_fmac_f32 v52, v219, v35
    v_fmac_f32 v53, v219, v39
    v_fmac_f32 v54, v219, v43
    v_fmac_f32 v55, v219, v47
    ds_read_b128 v[204:207], v30 offset:10240
    ds_read_b128 v[208:211], v30 offset:11264
    ds_read_b128 v[212:215], v30 offset:12288
    ds_read_b128 v[216:219], v30 offset:13312
    ds_read_b128 v[220:223], v30 offset:14336
    s_waitcnt lgkmcnt(4)
    v_mfma_f32_16x16x32_bf16 v[228:231], v[80:83], v[64:67], 0
    v_mfma_f32_16x16x32_bf16 v[232:235], v[108:111], v[92:95], 0
    v_mfma_f32_16x16x32_bf16 v[236:239], v[136:139], v[120:123], 0
    v_mfma_f32_16x16x32_bf16 v[240:243], v[164:167], v[148:151], 0
    s_waitcnt lgkmcnt(3)
    v_mfma_f32_16x16x32_bf16 v[32:35], v[80:83], v[68:71], 0
    v_mfma_f32_16x16x32_bf16 v[36:39], v[108:111], v[96:99], 0
    v_mfma_f32_16x16x32_bf16 v[40:43], v[136:139], v[124:127], 0
    v_mfma_f32_16x16x32_bf16 v[44:47], v[164:167], v[152:155], 0
    s_nop 2
    v_fmac_f32 v52, v204, v228
    v_fmac_f32 v53, v204, v232
    v_fmac_f32 v54, v204, v236
    v_fmac_f32 v55, v204, v240
    v_fmac_f32 v52, v205, v229
    v_fmac_f32 v53, v205, v233
    v_fmac_f32 v54, v205, v237
    v_fmac_f32 v55, v205, v241
    v_fmac_f32 v52, v206, v230
    v_fmac_f32 v53, v206, v234
    v_fmac_f32 v54, v206, v238
    v_fmac_f32 v55, v206, v242
    v_fmac_f32 v52, v207, v231
    v_fmac_f32 v53, v207, v235
    v_fmac_f32 v54, v207, v239
    v_fmac_f32 v55, v207, v243
    s_waitcnt lgkmcnt(2)
    v_mfma_f32_16x16x32_bf16 v[228:231], v[80:83], v[72:75], 0
    v_mfma_f32_16x16x32_bf16 v[232:235], v[108:111], v[100:103], 0
    v_mfma_f32_16x16x32_bf16 v[236:239], v[136:139], v[128:131], 0
    v_mfma_f32_16x16x32_bf16 v[240:243], v[164:167], v[156:159], 0
    v_fmac_f32 v52, v208, v32
    v_fmac_f32 v53, v208, v36
    v_fmac_f32 v54, v208, v40
    v_fmac_f32 v55, v208, v44
    v_fmac_f32 v52, v209, v33
    v_fmac_f32 v53, v209, v37
    v_fmac_f32 v54, v209, v41
    v_fmac_f32 v55, v209, v45
    v_fmac_f32 v52, v210, v34
    v_fmac_f32 v53, v210, v38
    v_fmac_f32 v54, v210, v42
    v_fmac_f32 v55, v210, v46
    v_fmac_f32 v52, v211, v35
    v_fmac_f32 v53, v211, v39
    v_fmac_f32 v54, v211, v43
    v_fmac_f32 v55, v211, v47
    s_waitcnt lgkmcnt(1)
    v_mfma_f32_16x16x32_bf16 v[32:35], v[80:83], v[76:79], 0
    v_mfma_f32_16x16x32_bf16 v[36:39], v[108:111], v[104:107], 0
    v_mfma_f32_16x16x32_bf16 v[40:43], v[136:139], v[132:135], 0
    v_mfma_f32_16x16x32_bf16 v[44:47], v[164:167], v[160:163], 0
    v_fmac_f32 v52, v212, v228
    v_fmac_f32 v53, v212, v232
    v_fmac_f32 v54, v212, v236
    v_fmac_f32 v55, v212, v240
    v_fmac_f32 v52, v213, v229
    v_fmac_f32 v53, v213, v233
    v_fmac_f32 v54, v213, v237
    v_fmac_f32 v55, v213, v241
    v_fmac_f32 v52, v214, v230
    v_fmac_f32 v53, v214, v234
    v_fmac_f32 v54, v214, v238
    v_fmac_f32 v55, v214, v242
    v_fmac_f32 v52, v215, v231
    v_fmac_f32 v53, v215, v235
    v_fmac_f32 v54, v215, v239
    v_fmac_f32 v55, v215, v243
    s_waitcnt lgkmcnt(0)
    v_mfma_f32_16x16x32_bf16 v[228:231], v[80:83], v[80:83], 0
    v_mfma_f32_16x16x32_bf16 v[232:235], v[108:111], v[108:111], 0
    v_mfma_f32_16x16x32_bf16 v[236:239], v[136:139], v[136:139], 0
    v_mfma_f32_16x16x32_bf16 v[240:243], v[164:167], v[164:167], 0
    v_fmac_f32 v52, v216, v32
    v_fmac_f32 v53, v216, v36
    v_fmac_f32 v54, v216, v40
    v_fmac_f32 v55, v216, v44
    v_fmac_f32 v52, v217, v33
    v_fmac_f32 v53, v217, v37
    v_fmac_f32 v54, v217, v41
    v_fmac_f32 v55, v217, v45
    v_fmac_f32 v52, v218, v34
    v_fmac_f32 v53, v218, v38
    v_fmac_f32 v54, v218, v42
    v_fmac_f32 v55, v218, v46
    v_fmac_f32 v52, v219, v35
    v_fmac_f32 v53, v219, v39
    v_fmac_f32 v54, v219, v43
    v_fmac_f32 v55, v219, v47
    v_mul_u32_u24 v248, 200, v6
    v_lshl_add_u32 v249, v5, 1, v248
    v_add_u32 v249, 157696, v249
    v_mul_u32_u24 v250, 200, v5
    v_lshl_add_u32 v250, v6, 1, v250
    v_add_u32 v250, 138688, v250
    s_add_u32 s64, s73, s57
    s_cmp_ge_u32 s64, 6
    s_cselect_b32 s65, 6, 0
    s_sub_u32 s64, s64, s65
    s_lshl_b32 s63, s64, 5
    v_add_u32 v252, s63, v249
    s_mul_i32 s63, s64, 3200
    v_add_u32 v253, s63, v250
    ds_read_u16 v244, v252
    ds_read_u16 v245, v253
    s_add_u32 s64, s73, s57
    s_add_u32 s64, s64, 4
    s_cmp_ge_u32 s64, 6
    s_cselect_b32 s65, 6, 0
    s_sub_u32 s64, s64, s65
    s_cmp_ge_u32 s64, 6
    s_cselect_b32 s65, 6, 0
    s_sub_u32 s64, s64, s65
    s_lshl_b32 s63, s64, 5
    v_add_u32 v252, s63, v249
    s_mul_i32 s63, s64, 3200
    v_add_u32 v253, s63, v250
    s_cmp_lg_u32 s57, 2
    s_cbranch_scc1 L_nosp
    v_lshrrev_b32 v252, 2, v5
    v_lshl_add_u32 v252, v252, 1, v248
    v_add_u32 v252, 157888, v252
L_nosp:
    ds_read_u16 v246, v252
    ds_read_u16 v247, v253
    s_waitcnt lgkmcnt(0)
    s_cmp_lg_u32 s57, 2
    s_cbranch_scc1 L_nosp2
    v_and_b32 v252, 3, v5
    v_cmp_eq_u32 vcc, 0, v252
    v_mov_b32 v247, 0
    s_nop 0
    v_cndmask_b32 v246, 0, v246, vcc
L_nosp2:
    v_lshlrev_b32 v244, 16, v244
    v_lshlrev_b32 v245, 16, v245
    v_lshlrev_b32 v246, 16, v246
    v_lshlrev_b32 v247, 16, v247
    v_add_f32 v244, v244, v245
    v_add_f32 v246, v246, v247
    v_lshlrev_b32 v252, 2, v1
    s_lshl_b32 s63, s57, 8
    s_add_u32 s63, s63, 123904
    v_add_u32 v252, s63, v252
    ds_write_b32 v252, v244
    s_cmp_eq_u32 s57, 3
    s_cbranch_scc1 L_no6w
    ds_write_b32 v252, v246 offset:1024
L_no6w:
    s_waitcnt lgkmcnt(0)
    s_nop 3
    s_waitcnt vmcnt(0)
    s_barrier
    s_setprio 2
    s_add_u32 m0, s5, 98304
    v_lshl_add_u32 v2, v200, 6, v10
    buffer_load_dwordx4 v2, s[28:31], 0 offen  lds
    buffer_load_dword v9, v11, s[16:19], 0 offen sc0 sc1
    s_setprio 0
    ds_read_b128 v[84:87], v21 offset:16384
    ds_read_b128 v[112:115], v22 offset:16384
    ds_read_b128 v[140:143], v23 offset:16384
    ds_read_b128 v[168:171], v24 offset:16384
    v_fmac_f32 v52, v220, v228
    v_fmac_f32 v53, v220, v232
    v_fmac_f32 v54, v220, v236
    v_fmac_f32 v55, v220, v240
    v_fmac_f32 v52, v221, v229
    v_fmac_f32 v53, v221, v233
    v_fmac_f32 v54, v221, v237
    v_fmac_f32 v55, v221, v241
    v_fmac_f32 v52, v222, v230
    v_fmac_f32 v53, v222, v234
    v_fmac_f32 v54, v222, v238
    v_fmac_f32 v55, v222, v242
    v_fmac_f32 v52, v223, v231
    v_fmac_f32 v53, v223, v235
    v_fmac_f32 v54, v223, v239
    v_fmac_f32 v55, v223, v243
    ds_read_b128 v[204:207], v30 offset:15360
    ds_read_b128 v[208:211], v30 offset:16384
    ds_read_b128 v[212:215], v30 offset:17408
    ds_read_b128 v[216:219], v30 offset:18432
    ds_read_b128 v[220:223], v30 offset:19456
    ds_read_b128 v[224:227], v30 offset:20480
    s_waitcnt lgkmcnt(5)
    v_mfma_f32_16x16x32_bf16 v[32:35], v[84:87], v[64:67], 0
    v_mfma_f32_16x16x32_bf16 v[36:39], v[112:115], v[92:95], 0
    v_mfma_f32_16x16x32_bf16 v[40:43], v[140:143], v[120:123], 0
    v_mfma_f32_16x16x32_bf16 v[44:47], v[168:171], v[148:151], 0
    s_waitcnt lgkmcnt(4)
    v_mfma_f32_16x16x32_bf16 v[228:231], v[84:87], v[68:71], 0
    v_mfma_f32_16x16x32_bf16 v[232:235], v[112:115], v[96:99], 0
    v_mfma_f32_16x16x32_bf16 v[236:239], v[140:143], v[124:127], 0
    v_mfma_f32_16x16x32_bf16 v[240:243], v[168:171], v[152:155], 0
    s_nop 2
    v_fmac_f32 v52, v204, v32
    v_fmac_f32 v53, v204, v36
    v_fmac_f32 v54, v204, v40
    v_fmac_f32 v55, v204, v44
    v_fmac_f32 v52, v205, v33
    v_fmac_f32 v53, v205, v37
    v_fmac_f32 v54, v205, v41
    v_fmac_f32 v55, v205, v45
    v_fmac_f32 v52, v206, v34
    v_fmac_f32 v53, v206, v38
    v_fmac_f32 v54, v206, v42
    v_fmac_f32 v55, v206, v46
    v_fmac_f32 v52, v207, v35
    v_fmac_f32 v53, v207, v39
    v_fmac_f32 v54, v207, v43
    v_fmac_f32 v55, v207, v47
    s_waitcnt lgkmcnt(3)
    v_mfma_f32_16x16x32_bf16 v[32:35], v[84:87], v[72:75], 0
    v_mfma_f32_16x16x32_bf16 v[36:39], v[112:115], v[100:103], 0
    v_mfma_f32_16x16x32_bf16 v[40:43], v[140:143], v[128:131], 0
    v_mfma_f32_16x16x32_bf16 v[44:47], v[168:171], v[156:159], 0
    v_fmac_f32 v52, v208, v228
    v_fmac_f32 v53, v208, v232
    v_fmac_f32 v54, v208, v236
    v_fmac_f32 v55, v208, v240
    v_fmac_f32 v52, v209, v229
    v_fmac_f32 v53, v209, v233
    v_fmac_f32 v54, v209, v237
    v_fmac_f32 v55, v209, v241
    v_fmac_f32 v52, v210, v230
    v_fmac_f32 v53, v210, v234
    v_fmac_f32 v54, v210, v238
    v_fmac_f32 v55, v210, v242
    v_fmac_f32 v52, v211, v231
    v_fmac_f32 v53, v211, v235
    v_fmac_f32 v54, v211, v239
    v_fmac_f32 v55, v211, v243
    s_waitcnt lgkmcnt(2)
    v_mfma_f32_16x16x32_bf16 v[228:231], v[84:87], v[76:79], 0
    v_mfma_f32_16x16x32_bf16 v[232:235], v[112:115], v[104:107], 0
    v_mfma_f32_16x16x32_bf16 v[236:239], v[140:143], v[132:135], 0
    v_mfma_f32_16x16x32_bf16 v[240:243], v[168:171], v[160:163], 0
    v_fmac_f32 v52, v212, v32
    v_fmac_f32 v53, v212, v36
    v_fmac_f32 v54, v212, v40
    v_fmac_f32 v55, v212, v44
    v_fmac_f32 v52, v213, v33
    v_fmac_f32 v53, v213, v37
    v_fmac_f32 v54, v213, v41
    v_fmac_f32 v55, v213, v45
    v_fmac_f32 v52, v214, v34
    v_fmac_f32 v53, v214, v38
    v_fmac_f32 v54, v214, v42
    v_fmac_f32 v55, v214, v46
    v_fmac_f32 v52, v215, v35
    v_fmac_f32 v53, v215, v39
    v_fmac_f32 v54, v215, v43
    v_fmac_f32 v55, v215, v47
    s_waitcnt lgkmcnt(1)
    v_mfma_f32_16x16x32_bf16 v[32:35], v[84:87], v[80:83], 0
    v_mfma_f32_16x16x32_bf16 v[36:39], v[112:115], v[108:111], 0
    v_mfma_f32_16x16x32_bf16 v[40:43], v[140:143], v[136:139], 0
    v_mfma_f32_16x16x32_bf16 v[44:47], v[168:171], v[164:167], 0
    v_fmac_f32 v52, v216, v228
    v_fmac_f32 v53, v216, v232
    v_fmac_f32 v54, v216, v236
    v_fmac_f32 v55, v216, v240
    v_fmac_f32 v52, v217, v229
    v_fmac_f32 v53, v217, v233
    v_fmac_f32 v54, v217, v237
    v_fmac_f32 v55, v217, v241
    v_fmac_f32 v52, v218, v230
    v_fmac_f32 v53, v218, v234
    v_fmac_f32 v54, v218, v238
    v_fmac_f32 v55, v218, v242
    v_fmac_f32 v52, v219, v231
    v_fmac_f32 v53, v219, v235
    v_fmac_f32 v54, v219, v239
    v_fmac_f32 v55, v219, v243
    s_waitcnt lgkmcnt(0)
    v_mfma_f32_16x16x32_bf16 v[228:231], v[84:87], v[84:87], 0
    v_mfma_f32_16x16x32_bf16 v[232:235], v[112:115], v[112:115], 0
    v_mfma_f32_16x16x32_bf16 v[236:239], v[140:143], v[140:143], 0
    v_mfma_f32_16x16x32_bf16 v[240:243], v[168:171], v[168:171], 0
    v_fmac_f32 v52, v220, v32
    v_fmac_f32 v53, v220, v36
    v_fmac_f32 v54, v220, v40
    v_fmac_f32 v55, v220, v44
    v_fmac_f32 v52, v221, v33
    v_fmac_f32 v53, v221, v37
    v_fmac_f32 v54, v221, v41
    v_fmac_f32 v55, v221, v45
    v_fmac_f32 v52, v222, v34
    v_fmac_f32 v53, v222, v38
    v_fmac_f32 v54, v222, v42
    v_fmac_f32 v55, v222, v46
    v_fmac_f32 v52, v223, v35
    v_fmac_f32 v53, v223, v39
    v_fmac_f32 v54, v223, v43
    v_fmac_f32 v55, v223, v47
    s_nop 3
    s_waitcnt vmcnt(1)
    s_barrier
    s_mov_b32 s64, 0x11111111
    s_mov_b32 s65, 0x11111111
    s_mov_b64 exec, s[64:65]
    ds_read_b128 v[88:91], v25
    ds_read_b128 v[116:119], v26
    ds_read_b128 v[144:147], v27
    ds_read_b128 v[172:175], v28
    s_mov_b64 exec, -1
    s_nop 3
    v_fmac_f32 v52, v224, v228
    v_fmac_f32 v53, v224, v232
    v_fmac_f32 v54, v224, v236
    v_fmac_f32 v55, v224, v240
    v_fmac_f32 v52, v225, v229
    v_fmac_f32 v53, v225, v233
    v_fmac_f32 v54, v225, v237
    v_fmac_f32 v55, v225, v241
    v_fmac_f32 v52, v226, v230
    v_fmac_f32 v53, v226, v234
    v_fmac_f32 v54, v226, v238
    v_fmac_f32 v55, v226, v242
    v_fmac_f32 v52, v227, v231
    v_fmac_f32 v53, v227, v235
    v_fmac_f32 v54, v227, v239
    v_fmac_f32 v55, v227, v243
    ds_read_b32 v204, v31 offset:0
    ds_read_b32 v205, v31 offset:256
    ds_read_b32 v206, v31 offset:512
    ds_read_b32 v207, v31 offset:768
    ds_read_b32 v208, v31 offset:1024
    ds_read_b32 v209, v31 offset:1280
    ds_read_b32 v210, v31 offset:1536
    s_waitcnt lgkmcnt(6)
    v_mfma_f32_16x16x32_bf16 v[32:35], v[88:91], v[64:67], 0
    v_mfma_f32_16x16x32_bf16 v[36:39], v[116:119], v[92:95], 0
    v_mfma_f32_16x16x32_bf16 v[40:43], v[144:147], v[120:123], 0
    v_mfma_f32_16x16x32_bf16 v[44:47], v[172:175], v[148:151], 0
    s_waitcnt lgkmcnt(5)
    v_mfma_f32_16x16x32_bf16 v[228:231], v[88:91], v[68:71], 0
    v_mfma_f32_16x16x32_bf16 v[232:235], v[116:119], v[96:99], 0
    v_mfma_f32_16x16x32_bf16 v[236:239], v[144:147], v[124:127], 0
    v_mfma_f32_16x16x32_bf16 v[240:243], v[172:175], v[152:155], 0
    s_nop 2
    v_fmac_f32 v52, v204, v32
    v_fmac_f32 v53, v204, v36
    v_fmac_f32 v54, v204, v40
    v_fmac_f32 v55, v204, v44
    s_waitcnt lgkmcnt(4)
    v_mfma_f32_16x16x32_bf16 v[32:35], v[88:91], v[72:75], 0
    v_mfma_f32_16x16x32_bf16 v[36:39], v[116:119], v[100:103], 0
    v_mfma_f32_16x16x32_bf16 v[40:43], v[144:147], v[128:131], 0
    v_mfma_f32_16x16x32_bf16 v[44:47], v[172:175], v[156:159], 0
    s_nop 2
    v_fmac_f32 v52, v205, v228
    v_fmac_f32 v53, v205, v232
    v_fmac_f32 v54, v205, v236
    v_fmac_f32 v55, v205, v240
    s_waitcnt lgkmcnt(3)
    v_mfma_f32_16x16x32_bf16 v[228:231], v[88:91], v[76:79], 0
    v_mfma_f32_16x16x32_bf16 v[232:235], v[116:119], v[104:107], 0
    v_mfma_f32_16x16x32_bf16 v[236:239], v[144:147], v[132:135], 0
    v_mfma_f32_16x16x32_bf16 v[240:243], v[172:175], v[160:163], 0
    s_nop 2
    v_fmac_f32 v52, v206, v32
    v_fmac_f32 v53, v206, v36
    v_fmac_f32 v54, v206, v40
    v_fmac_f32 v55, v206, v44
    s_waitcnt lgkmcnt(2)
    v_mfma_f32_16x16x32_bf16 v[32:35], v[88:91], v[80:83], 0
    v_mfma_f32_16x16x32_bf16 v[36:39], v[116:119], v[108:111], 0
    v_mfma_f32_16x16x32_bf16 v[40:43], v[144:147], v[136:139], 0
    v_mfma_f32_16x16x32_bf16 v[44:47], v[172:175], v[164:167], 0
    s_nop 2
    v_fmac_f32 v52, v207, v228
    v_fmac_f32 v53, v207, v232
    v_fmac_f32 v54, v207, v236
    v_fmac_f32 v55, v207, v240
    s_waitcnt lgkmcnt(1)
    v_mfma_f32_16x16x32_bf16 v[228:231], v[88:91], v[84:87], 0
    v_mfma_f32_16x16x32_bf16 v[232:235], v[116:119], v[112:115], 0
    v_mfma_f32_16x16x32_bf16 v[236:239], v[144:147], v[140:143], 0
    v_mfma_f32_16x16x32_bf16 v[240:243], v[172:175], v[168:171], 0
    s_nop 2
    v_fmac_f32 v52, v208, v32
    v_fmac_f32 v53, v208, v36
    v_fmac_f32 v54, v208, v40
    v_fmac_f32 v55, v208, v44
    s_waitcnt lgkmcnt(0)
    v_mfma_f32_16x16x32_bf16 v[32:35], v[88:91], v[88:91], 0
    v_mfma_f32_16x16x32_bf16 v[36:39], v[116:119], v[116:119], 0
    v_mfma_f32_16x16x32_bf16 v[40:43], v[144:147], v[144:147], 0
    v_mfma_f32_16x16x32_bf16 v[44:47], v[172:175], v[172:175], 0
    s_nop 2
    v_fmac_f32 v52, v209, v228
    v_fmac_f32 v53, v209, v232
    v_fmac_f32 v54, v209, v236
    v_fmac_f32 v55, v209, v240
    s_nop 3
    s_nop 3
    v_fmac_f32 v52, v210, v32
    v_fmac_f32 v53, v210, v36
    v_fmac_f32 v54, v210, v40
    v_fmac_f32 v55, v210, v44
    v_lshlrev_b32 v56, 16, v56
    s_branch L_gelu
L_M:
    v_lshlrev_b32 v7, 11, v6
    v_lshrrev_b32 v2, 3, v5
    v_lshl_add_u32 v7, v2, 10, v7
    v_and_b32 v2, 7, v5
    v_lshl_add_u32 v7, v2, 4, v7
    s_lshl_b32 s63, s57, 15
    s_lshl_b32 s68, s70, 7
    s_add_u32 s63, s63, s68
    v_add_u32 v7, s63, v7
    s_lshl_b32 s71, s73, 17
    v_lshlrev_b32 v10, 4, v6
    v_mov_b32 v224, 0
    v_mov_b32 v225, 0
    v_mov_b32 v226, 0
    v_mov_b32 v227, 0
    v_mov_b32 v228, 0
    v_mov_b32 v229, 0
    v_mov_b32 v230, 0
    v_mov_b32 v231, 0
    v_mov_b32 v232, 0
    v_mov_b32 v233, 0
    v_mov_b32 v234, 0
    v_mov_b32 v235, 0
    v_mov_b32 v236, 0
    v_mov_b32 v237, 0
    v_mov_b32 v238, 0
    v_mov_b32 v239, 0
    v_mov_b32 v240, 0
    v_mov_b32 v241, 0
    v_mov_b32 v242, 0
    v_mov_b32 v243, 0
    v_mov_b32 v244, 0
    v_mov_b32 v245, 0
    v_mov_b32 v246, 0
    v_mov_b32 v247, 0
    v_mov_b32 v248, 0
    v_mov_b32 v249, 0
    v_mov_b32 v250, 0
    v_mov_b32 v251, 0
    v_mov_b32 v252, 0
    v_mov_b32 v253, 0
    v_mov_b32 v254, 0
    v_mov_b32 v255, 0
    v_lshrrev_b32 v2, 3, v5
    s_lshr_b32 s63, s57, 1
    v_xor_b32 v2, s63, v2
    v_and_b32 v2, 1, v2
    v_lshlrev_b32 v2, 1, v2
    v_xor_b32 v2, v2, v6
    v_lshlrev_b32 v2, 4, v2
    s_lshl_b32 s63, s57, 12
    v_add_u32 v2, s63, v2
    v_add_u32 v3, 0, v5
    v_and_b32 v3, 3, v3
    v_and_b32 v4, 12, v5
    v_or_b32 v3, v3, v4
    v_lshl_add_u32 v28, v3, 6, v2
    v_add_u32 v28, 0, v28
    v_add_u32 v3, 1, v5
    v_and_b32 v3, 3, v3
    v_and_b32 v4, 12, v5
    v_or_b32 v3, v3, v4
    v_lshl_add_u32 v29, v3, 6, v2
    v_add_u32 v29, 1024, v29
    v_add_u32 v3, 2, v5
    v_and_b32 v3, 3, v3
    v_and_b32 v4, 12, v5
    v_or_b32 v3, v3, v4
    v_lshl_add_u32 v30, v3, 6, v2
    v_add_u32 v30, 2048, v30
    v_add_u32 v3, 3, v5
    v_and_b32 v3, 3, v3
    v_and_b32 v4, 12, v5
    v_or_b32 v3, v3, v4
    v_lshl_add_u32 v31, v3, 6, v2
    v_add_u32 v31, 3072, v31
    s_mov_b32 s8, 0x00ff00ff
    s_mov_b32 s9, 0x00ff00ff
    s_mov_b32 s10, 0xff00ff00
    s_mov_b32 s11, 0xff00ff00
    s_xor_b32 s63, s70, 1
    s_lshl_b32 s63, s63, 4
    v_add_u32 v3, s63, v5
    v_mul_u32_u24 v3, 400, v3
    s_lshl_b32 s64, s57, 4
    s_add_u32 s64, s64, 125696
    v_add_u32 v16, s64, v3
    s_lshl_b32 s64, s57, 2
    s_add_u32 s64, s64, 126080
    v_add_u32 v17, s64, v3
    s_add_u32 s63, s73, 1
    s_cmp_ge_u32 s63, 6
    s_cselect_b32 s68, 6, 0
    s_sub_u32 s63, s63, s68
    s_lshl_b32 s63, s63, 6
    v_add_u32 v129, s63, v16
    s_add_u32 s63, s73, 2
    s_cmp_ge_u32 s63, 6
    s_cselect_b32 s68, 6, 0
    s_sub_u32 s63, s63, s68
    s_lshl_b32 s63, s63, 6
    v_add_u32 v130, s63, v16
    s_add_u32 s63, s73, 3
    s_cmp_ge_u32 s63, 6
    s_cselect_b32 s68, 6, 0
    s_sub_u32 s63, s63, s68
    s_lshl_b32 s63, s63, 6
    v_add_u32 v131, s63, v16
    s_add_u32 s63, s73, 4
    s_cmp_ge_u32 s63, 6
    s_cselect_b32 s68, 6, 0
    s_sub_u32 s63, s63, s68
    s_lshl_b32 s63, s63, 6
    v_add_u32 v132, s63, v16
    s_add_u32 s63, s73, 5
    s_cmp_ge_u32 s63, 6
    s_cselect_b32 s68, 6, 0
    s_sub_u32 s63, s63, s68
    s_lshl_b32 s63, s63, 6
    v_add_u32 v133, s63, v16
    buffer_load_ushort v13, v8, s[44:47], 0 offen
    buffer_load_ushort v14, v8, s[48:51], 0 offen
    buffer_load_dword v12, v11, s[12:15], 0 offen offset:4
    s_waitcnt vmcnt(3)
    v_lshl_add_u32 v2, v176, 6, v10
    buffer_load_dwordx4 v[48:51], v2, s[28:31], 0 offen
    v_lshl_add_u32 v2, v177, 6, v10
    buffer_load_dwordx4 v[52:55], v2, s[28:31], 0 offen
    v_lshl_add_u32 v2, v178, 6, v10
    buffer_load_dwordx4 v[56:59], v2, s[28:31], 0 offen
    v_lshl_add_u32 v2, v179, 6, v10
    buffer_load_dwordx4 v[60:63], v2, s[28:31], 0 offen
    s_add_u32 s72, s71, 0
    buffer_load_dwordx4 v[64:67], v7, s[36:39], s72 offen offset:0
    buffer_load_dwordx4 v[68:71], v7, s[36:39], s72 offen offset:256
    buffer_load_dwordx4 v[72:75], v7, s[36:39], s72 offen offset:512
    buffer_load_dwordx4 v[76:79], v7, s[36:39], s72 offen offset:768
    s_add_u32 s72, s71, 8192
    buffer_load_dwordx4 v[80:83], v7, s[36:39], s72 offen offset:0
    buffer_load_dwordx4 v[84:87], v7, s[36:39], s72 offen offset:256
    buffer_load_dwordx4 v[88:91], v7, s[36:39], s72 offen offset:512
    buffer_load_dwordx4 v[92:95], v7, s[36:39], s72 offen offset:768
    s_add_u32 s72, s71, 16384
    buffer_load_dwordx4 v[96:99], v7, s[36:39], s72 offen offset:0
    buffer_load_dwordx4 v[100:103], v7, s[36:39], s72 offen offset:256
    buffer_load_dwordx4 v[104:107], v7, s[36:39], s72 offen offset:512
    buffer_load_dwordx4 v[108:111], v7, s[36:39], s72 offen offset:768
    s_add_u32 s72, s71, 24576
    buffer_load_dwordx4 v[112:115], v7, s[36:39], s72 offen offset:0
    buffer_load_dwordx4 v[116:119], v7, s[36:39], s72 offen offset:256
    buffer_load_dwordx4 v[120:123], v7, s[36:39], s72 offen offset:512
    buffer_load_dwordx4 v[124:127], v7, s[36:39], s72 offen offset:768
    s_add_u32 s71, s71, 131072
    s_cmp_eq_u32 s71, 786432
    s_cselect_b32 s71, 0, s71
    s_setprio 1
    s_barrier
    ds_read_b128 v[32:35], v28
    ds_read_b128 v[36:39], v29
    ds_read_b128 v[40:43], v30
    ds_read_b128 v[44:47], v31
    ds_read_b128 v[180:183], v129
    ds_read_b128 v[184:187], v130
    ds_read_b128 v[188:191], v131
    ds_read_b128 v[192:195], v132
    ds_read_b128 v[196:199], v133
    ds_read_b32 v200, v17
    s_waitcnt lgkmcnt(0)
    s_add_u32 s72, s71, 0
    s_waitcnt lgkmcnt(3)
    s_waitcnt vmcnt(12)
    s_mov_b64 vcc, s[8:9]
    v_cndmask_b32_dpp v128, v66, v64, vcc row_ror:8 row_mask:0xf bank_mask:0xf
    v_cndmask_b32_dpp v129, v67, v65, vcc row_ror:8 row_mask:0xf bank_mask:0xf
    v_cndmask_b32_dpp v130, v70, v68, vcc row_ror:8 row_mask:0xf bank_mask:0xf
    v_cndmask_b32_dpp v131, v71, v69, vcc row_ror:8 row_mask:0xf bank_mask:0xf
    v_cndmask_b32_dpp v132, v74, v72, vcc row_ror:8 row_mask:0xf bank_mask:0xf
    v_cndmask_b32_dpp v133, v75, v73, vcc row_ror:8 row_mask:0xf bank_mask:0xf
    v_cndmask_b32_dpp v134, v78, v76, vcc row_ror:8 row_mask:0xf bank_mask:0xf
    v_cndmask_b32_dpp v135, v79, v77, vcc row_ror:8 row_mask:0xf bank_mask:0xf
    s_mov_b64 vcc, s[10:11]
    v_cndmask_b32_dpp v66, v64, v66, vcc row_ror:8 row_mask:0xf bank_mask:0xf
    v_cndmask_b32_dpp v67, v65, v67, vcc row_ror:8 row_mask:0xf bank_mask:0xf
    v_cndmask_b32_dpp v70, v68, v70, vcc row_ror:8 row_mask:0xf bank_mask:0xf
    v_cndmask_b32_dpp v71, v69, v71, vcc row_ror:8 row_mask:0xf bank_mask:0xf
    v_cndmask_b32_dpp v74, v72, v74, vcc row_ror:8 row_mask:0xf bank_mask:0xf
    v_cndmask_b32_dpp v75, v73, v75, vcc row_ror:8 row_mask:0xf bank_mask:0xf
    v_cndmask_b32_dpp v78, v76, v78, vcc row_ror:8 row_mask:0xf bank_mask:0xf
    v_cndmask_b32_dpp v79, v77, v79, vcc row_ror:8 row_mask:0xf bank_mask:0xf
    v_perm_b32 v16, v130, v128, s60
    v_perm_b32 v17, v134, v132, s60
    v_perm_b32 v18, v70, v66, s60
    v_perm_b32 v19, v78, v74, s60
    v_perm_b32 v20, v130, v128, s61
    v_perm_b32 v21, v134, v132, s61
    v_perm_b32 v22, v70, v66, s61
    v_perm_b32 v23, v78, v74, s61
    v_mfma_f32_16x16x32_bf16 v[224:227], v[32:35], v[16:19], v[224:227]
    v_mfma_f32_16x16x32_bf16 v[240:243], v[48:51], v[16:19], v[240:243]
    v_perm_b32 v24, v131, v129, s60
    v_perm_b32 v25, v135, v133, s60
    v_perm_b32 v26, v71, v67, s60
    v_perm_b32 v27, v79, v75, s60
    v_mfma_f32_16x16x32_bf16 v[228:231], v[32:35], v[20:23], v[228:231]
    v_mfma_f32_16x16x32_bf16 v[244:247], v[48:51], v[20:23], v[244:247]
    v_perm_b32 v16, v131, v129, s61
    v_perm_b32 v17, v135, v133, s61
    v_perm_b32 v18, v71, v67, s61
    v_perm_b32 v19, v79, v75, s61
    v_mfma_f32_16x16x32_bf16 v[232:235], v[32:35], v[24:27], v[232:235]
    v_mfma_f32_16x16x32_bf16 v[248:251], v[48:51], v[24:27], v[248:251]
    buffer_load_dwordx4 v[64:67], v7, s[36:39], s72 offen offset:0
    buffer_load_dwordx4 v[68:71], v7, s[36:39], s72 offen offset:256
    buffer_load_dwordx4 v[72:75], v7, s[36:39], s72 offen offset:512
    buffer_load_dwordx4 v[76:79], v7, s[36:39], s72 offen offset:768
    v_mfma_f32_16x16x32_bf16 v[236:239], v[32:35], v[16:19], v[236:239]
    v_mfma_f32_16x16x32_bf16 v[252:255], v[48:51], v[16:19], v[252:255]
    v_lshl_add_u32 v2, v180, 6, v10
    buffer_load_dwordx4 v[48:51], v2, s[28:31], 0 offen
    v_add_u32 v28, 16384, v28
    v_add_u32 v29, 16384, v29
    v_add_u32 v30, 16384, v30
    v_add_u32 v31, 16384, v31
    s_add_u32 s72, s71, 8192
    s_waitcnt lgkmcnt(2)
    s_waitcnt vmcnt(13)
    s_mov_b64 vcc, s[8:9]
    v_cndmask_b32_dpp v128, v82, v80, vcc row_ror:8 row_mask:0xf bank_mask:0xf
    v_cndmask_b32_dpp v129, v83, v81, vcc row_ror:8 row_mask:0xf bank_mask:0xf
    v_cndmask_b32_dpp v130, v86, v84, vcc row_ror:8 row_mask:0xf bank_mask:0xf
    v_cndmask_b32_dpp v131, v87, v85, vcc row_ror:8 row_mask:0xf bank_mask:0xf
    v_cndmask_b32_dpp v132, v90, v88, vcc row_ror:8 row_mask:0xf bank_mask:0xf
    v_cndmask_b32_dpp v133, v91, v89, vcc row_ror:8 row_mask:0xf bank_mask:0xf
    v_cndmask_b32_dpp v134, v94, v92, vcc row_ror:8 row_mask:0xf bank_mask:0xf
    v_cndmask_b32_dpp v135, v95, v93, vcc row_ror:8 row_mask:0xf bank_mask:0xf
    s_mov_b64 vcc, s[10:11]
    v_cndmask_b32_dpp v82, v80, v82, vcc row_ror:8 row_mask:0xf bank_mask:0xf
    v_cndmask_b32_dpp v83, v81, v83, vcc row_ror:8 row_mask:0xf bank_mask:0xf
    v_cndmask_b32_dpp v86, v84, v86, vcc row_ror:8 row_mask:0xf bank_mask:0xf
    v_cndmask_b32_dpp v87, v85, v87, vcc row_ror:8 row_mask:0xf bank_mask:0xf
    v_cndmask_b32_dpp v90, v88, v90, vcc row_ror:8 row_mask:0xf bank_mask:0xf
    v_cndmask_b32_dpp v91, v89, v91, vcc row_ror:8 row_mask:0xf bank_mask:0xf
    v_cndmask_b32_dpp v94, v92, v94, vcc row_ror:8 row_mask:0xf bank_mask:0xf
    v_cndmask_b32_dpp v95, v93, v95, vcc row_ror:8 row_mask:0xf bank_mask:0xf
    v_perm_b32 v16, v130, v128, s60
    v_perm_b32 v17, v134, v132, s60
    v_perm_b32 v18, v86, v82, s60
    v_perm_b32 v19, v94, v90, s60
    v_perm_b32 v20, v130, v128, s61
    v_perm_b32 v21, v134, v132, s61
    v_perm_b32 v22, v86, v82, s61
    v_perm_b32 v23, v94, v90, s61
    v_mfma_f32_16x16x32_bf16 v[224:227], v[36:39], v[16:19], v[224:227]
    v_mfma_f32_16x16x32_bf16 v[240:243], v[52:55], v[16:19], v[240:243]
    v_perm_b32 v24, v131, v129, s60
    v_perm_b32 v25, v135, v133, s60
    v_perm_b32 v26, v87, v83, s60
    v_perm_b32 v27, v95, v91, s60
    v_mfma_f32_16x16x32_bf16 v[228:231], v[36:39], v[20:23], v[228:231]
    v_mfma_f32_16x16x32_bf16 v[244:247], v[52:55], v[20:23], v[244:247]
    v_perm_b32 v16, v131, v129, s61
    v_perm_b32 v17, v135, v133, s61
    v_perm_b32 v18, v87, v83, s61
    v_perm_b32 v19, v95, v91, s61
    v_mfma_f32_16x16x32_bf16 v[232:235], v[36:39], v[24:27], v[232:235]
    v_mfma_f32_16x16x32_bf16 v[248:251], v[52:55], v[24:27], v[248:251]
    buffer_load_dwordx4 v[80:83], v7, s[36:39], s72 offen offset:0
    buffer_load_dwordx4 v[84:87], v7, s[36:39], s72 offen offset:256
    buffer_load_dwordx4 v[88:91], v7, s[36:39], s72 offen offset:512
    buffer_load_dwordx4 v[92:95], v7, s[36:39], s72 offen offset:768
    v_mfma_f32_16x16x32_bf16 v[236:239], v[36:39], v[16:19], v[236:239]
    v_mfma_f32_16x16x32_bf16 v[252:255], v[52:55], v[16:19], v[252:255]
    v_lshl_add_u32 v2, v181, 6, v10
    buffer_load_dwordx4 v[52:55], v2, s[28:31], 0 offen
    s_add_u32 s72, s71, 16384
    s_waitcnt lgkmcnt(1)
    s_waitcnt vmcnt(14)
    s_mov_b64 vcc, s[8:9]
    v_cndmask_b32_dpp v128, v98, v96, vcc row_ror:8 row_mask:0xf bank_mask:0xf
    v_cndmask_b32_dpp v129, v99, v97, vcc row_ror:8 row_mask:0xf bank_mask:0xf
    v_cndmask_b32_dpp v130, v102, v100, vcc row_ror:8 row_mask:0xf bank_mask:0xf
    v_cndmask_b32_dpp v131, v103, v101, vcc row_ror:8 row_mask:0xf bank_mask:0xf
    v_cndmask_b32_dpp v132, v106, v104, vcc row_ror:8 row_mask:0xf bank_mask:0xf
    v_cndmask_b32_dpp v133, v107, v105, vcc row_ror:8 row_mask:0xf bank_mask:0xf
    v_cndmask_b32_dpp v134, v110, v108, vcc row_ror:8 row_mask:0xf bank_mask:0xf
    v_cndmask_b32_dpp v135, v111, v109, vcc row_ror:8 row_mask:0xf bank_mask:0xf
    s_mov_b64 vcc, s[10:11]
    v_cndmask_b32_dpp v98, v96, v98, vcc row_ror:8 row_mask:0xf bank_mask:0xf
    v_cndmask_b32_dpp v99, v97, v99, vcc row_ror:8 row_mask:0xf bank_mask:0xf
    v_cndmask_b32_dpp v102, v100, v102, vcc row_ror:8 row_mask:0xf bank_mask:0xf
    v_cndmask_b32_dpp v103, v101, v103, vcc row_ror:8 row_mask:0xf bank_mask:0xf
    v_cndmask_b32_dpp v106, v104, v106, vcc row_ror:8 row_mask:0xf bank_mask:0xf
    v_cndmask_b32_dpp v107, v105, v107, vcc row_ror:8 row_mask:0xf bank_mask:0xf
    v_cndmask_b32_dpp v110, v108, v110, vcc row_ror:8 row_mask:0xf bank_mask:0xf
    v_cndmask_b32_dpp v111, v109, v111, vcc row_ror:8 row_mask:0xf bank_mask:0xf
    v_perm_b32 v16, v130, v128, s60
    v_perm_b32 v17, v134, v132, s60
    v_perm_b32 v18, v102, v98, s60
    v_perm_b32 v19, v110, v106, s60
    v_perm_b32 v20, v130, v128, s61
    v_perm_b32 v21, v134, v132, s61
    v_perm_b32 v22, v102, v98, s61
    v_perm_b32 v23, v110, v106, s61
    v_mfma_f32_16x16x32_bf16 v[224:227], v[40:43], v[16:19], v[224:227]
    v_mfma_f32_16x16x32_bf16 v[240:243], v[56:59], v[16:19], v[240:243]
    v_perm_b32 v24, v131, v129, s60
    v_perm_b32 v25, v135, v133, s60
    v_perm_b32 v26, v103, v99, s60
    v_perm_b32 v27, v111, v107, s60
    v_mfma_f32_16x16x32_bf16 v[228:231], v[40:43], v[20:23], v[228:231]
    v_mfma_f32_16x16x32_bf16 v[244:247], v[56:59], v[20:23], v[244:247]
    v_perm_b32 v16, v131, v129, s61
    v_perm_b32 v17, v135, v133, s61
    v_perm_b32 v18, v103, v99, s61
    v_perm_b32 v19, v111, v107, s61
    v_mfma_f32_16x16x32_bf16 v[232:235], v[40:43], v[24:27], v[232:235]
    v_mfma_f32_16x16x32_bf16 v[248:251], v[56:59], v[24:27], v[248:251]
    buffer_load_dwordx4 v[96:99], v7, s[36:39], s72 offen offset:0
    buffer_load_dwordx4 v[100:103], v7, s[36:39], s72 offen offset:256
    buffer_load_dwordx4 v[104:107], v7, s[36:39], s72 offen offset:512
    buffer_load_dwordx4 v[108:111], v7, s[36:39], s72 offen offset:768
    v_mfma_f32_16x16x32_bf16 v[236:239], v[40:43], v[16:19], v[236:239]
    v_mfma_f32_16x16x32_bf16 v[252:255], v[56:59], v[16:19], v[252:255]
    v_lshl_add_u32 v2, v182, 6, v10
    buffer_load_dwordx4 v[56:59], v2, s[28:31], 0 offen
    s_add_u32 s72, s71, 24576
    s_waitcnt lgkmcnt(0)
    s_waitcnt vmcnt(15)
    s_mov_b64 vcc, s[8:9]
    v_cndmask_b32_dpp v128, v114, v112, vcc row_ror:8 row_mask:0xf bank_mask:0xf
    v_cndmask_b32_dpp v129, v115, v113, vcc row_ror:8 row_mask:0xf bank_mask:0xf
    v_cndmask_b32_dpp v130, v118, v116, vcc row_ror:8 row_mask:0xf bank_mask:0xf
    v_cndmask_b32_dpp v131, v119, v117, vcc row_ror:8 row_mask:0xf bank_mask:0xf
    v_cndmask_b32_dpp v132, v122, v120, vcc row_ror:8 row_mask:0xf bank_mask:0xf
    v_cndmask_b32_dpp v133, v123, v121, vcc row_ror:8 row_mask:0xf bank_mask:0xf
    v_cndmask_b32_dpp v134, v126, v124, vcc row_ror:8 row_mask:0xf bank_mask:0xf
    v_cndmask_b32_dpp v135, v127, v125, vcc row_ror:8 row_mask:0xf bank_mask:0xf
    s_mov_b64 vcc, s[10:11]
    v_cndmask_b32_dpp v114, v112, v114, vcc row_ror:8 row_mask:0xf bank_mask:0xf
    v_cndmask_b32_dpp v115, v113, v115, vcc row_ror:8 row_mask:0xf bank_mask:0xf
    v_cndmask_b32_dpp v118, v116, v118, vcc row_ror:8 row_mask:0xf bank_mask:0xf
    v_cndmask_b32_dpp v119, v117, v119, vcc row_ror:8 row_mask:0xf bank_mask:0xf
    v_cndmask_b32_dpp v122, v120, v122, vcc row_ror:8 row_mask:0xf bank_mask:0xf
    v_cndmask_b32_dpp v123, v121, v123, vcc row_ror:8 row_mask:0xf bank_mask:0xf
    v_cndmask_b32_dpp v126, v124, v126, vcc row_ror:8 row_mask:0xf bank_mask:0xf
    v_cndmask_b32_dpp v127, v125, v127, vcc row_ror:8 row_mask:0xf bank_mask:0xf
    v_perm_b32 v16, v130, v128, s60
    v_perm_b32 v17, v134, v132, s60
    v_perm_b32 v18, v118, v114, s60
    v_perm_b32 v19, v126, v122, s60
    v_perm_b32 v20, v130, v128, s61
    v_perm_b32 v21, v134, v132, s61
    v_perm_b32 v22, v118, v114, s61
    v_perm_b32 v23, v126, v122, s61
    v_mfma_f32_16x16x32_bf16 v[224:227], v[44:47], v[16:19], v[224:227]
    v_mfma_f32_16x16x32_bf16 v[240:243], v[60:63], v[16:19], v[240:243]
    v_perm_b32 v24, v131, v129, s60
    v_perm_b32 v25, v135, v133, s60
    v_perm_b32 v26, v119, v115, s60
    v_perm_b32 v27, v127, v123, s60
    v_mfma_f32_16x16x32_bf16 v[228:231], v[44:47], v[20:23], v[228:231]
    v_mfma_f32_16x16x32_bf16 v[244:247], v[60:63], v[20:23], v[244:247]
    v_perm_b32 v16, v131, v129, s61
    v_perm_b32 v17, v135, v133, s61
    v_perm_b32 v18, v119, v115, s61
    v_perm_b32 v19, v127, v123, s61
    v_mfma_f32_16x16x32_bf16 v[232:235], v[44:47], v[24:27], v[232:235]
    v_mfma_f32_16x16x32_bf16 v[248:251], v[60:63], v[24:27], v[248:251]
    buffer_load_dwordx4 v[112:115], v7, s[36:39], s72 offen offset:0
    buffer_load_dwordx4 v[116:119], v7, s[36:39], s72 offen offset:256
    buffer_load_dwordx4 v[120:123], v7, s[36:39], s72 offen offset:512
    buffer_load_dwordx4 v[124:127], v7, s[36:39], s72 offen offset:768
    v_mfma_f32_16x16x32_bf16 v[236:239], v[44:47], v[16:19], v[236:239]
    v_mfma_f32_16x16x32_bf16 v[252:255], v[60:63], v[16:19], v[252:255]
    v_lshl_add_u32 v2, v183, 6, v10
    buffer_load_dwordx4 v[60:63], v2, s[28:31], 0 offen
    s_add_u32 s71, s71, 131072
    s_cmp_eq_u32 s71, 786432
    s_cselect_b32 s71, 0, s71
    s_barrier
    ds_read_b128 v[32:35], v28
    ds_read_b128 v[36:39], v29
    ds_read_b128 v[40:43], v30
    ds_read_b128 v[44:47], v31
    s_add_u32 s72, s71, 0
    s_waitcnt lgkmcnt(3)
    s_waitcnt vmcnt(15)
    s_mov_b64 vcc, s[8:9]
    v_cndmask_b32_dpp v128, v66, v64, vcc row_ror:8 row_mask:0xf bank_mask:0xf
    v_cndmask_b32_dpp v129, v67, v65, vcc row_ror:8 row_mask:0xf bank_mask:0xf
    v_cndmask_b32_dpp v130, v70, v68, vcc row_ror:8 row_mask:0xf bank_mask:0xf
    v_cndmask_b32_dpp v131, v71, v69, vcc row_ror:8 row_mask:0xf bank_mask:0xf
    v_cndmask_b32_dpp v132, v74, v72, vcc row_ror:8 row_mask:0xf bank_mask:0xf
    v_cndmask_b32_dpp v133, v75, v73, vcc row_ror:8 row_mask:0xf bank_mask:0xf
    v_cndmask_b32_dpp v134, v78, v76, vcc row_ror:8 row_mask:0xf bank_mask:0xf
    v_cndmask_b32_dpp v135, v79, v77, vcc row_ror:8 row_mask:0xf bank_mask:0xf
    s_mov_b64 vcc, s[10:11]
    v_cndmask_b32_dpp v66, v64, v66, vcc row_ror:8 row_mask:0xf bank_mask:0xf
    v_cndmask_b32_dpp v67, v65, v67, vcc row_ror:8 row_mask:0xf bank_mask:0xf
    v_cndmask_b32_dpp v70, v68, v70, vcc row_ror:8 row_mask:0xf bank_mask:0xf
    v_cndmask_b32_dpp v71, v69, v71, vcc row_ror:8 row_mask:0xf bank_mask:0xf
    v_cndmask_b32_dpp v74, v72, v74, vcc row_ror:8 row_mask:0xf bank_mask:0xf
    v_cndmask_b32_dpp v75, v73, v75, vcc row_ror:8 row_mask:0xf bank_mask:0xf
    v_cndmask_b32_dpp v78, v76, v78, vcc row_ror:8 row_mask:0xf bank_mask:0xf
    v_cndmask_b32_dpp v79, v77, v79, vcc row_ror:8 row_mask:0xf bank_mask:0xf
    v_perm_b32 v16, v130, v128, s60
    v_perm_b32 v17, v134, v132, s60
    v_perm_b32 v18, v70, v66, s60
    v_perm_b32 v19, v78, v74, s60
    v_perm_b32 v20, v130, v128, s61
    v_perm_b32 v21, v134, v132, s61
    v_perm_b32 v22, v70, v66, s61
    v_perm_b32 v23, v78, v74, s61
    v_mfma_f32_16x16x32_bf16 v[224:227], v[32:35], v[16:19], v[224:227]
    v_mfma_f32_16x16x32_bf16 v[240:243], v[48:51], v[16:19], v[240:243]
    v_perm_b32 v24, v131, v129, s60
    v_perm_b32 v25, v135, v133, s60
    v_perm_b32 v26, v71, v67, s60
    v_perm_b32 v27, v79, v75, s60
    v_mfma_f32_16x16x32_bf16 v[228:231], v[32:35], v[20:23], v[228:231]
    v_mfma_f32_16x16x32_bf16 v[244:247], v[48:51], v[20:23], v[244:247]
    v_perm_b32 v16, v131, v129, s61
    v_perm_b32 v17, v135, v133, s61
    v_perm_b32 v18, v71, v67, s61
    v_perm_b32 v19, v79, v75, s61
    v_mfma_f32_16x16x32_bf16 v[232:235], v[32:35], v[24:27], v[232:235]
    v_mfma_f32_16x16x32_bf16 v[248:251], v[48:51], v[24:27], v[248:251]
    buffer_load_dwordx4 v[64:67], v7, s[36:39], s72 offen offset:0
    buffer_load_dwordx4 v[68:71], v7, s[36:39], s72 offen offset:256
    buffer_load_dwordx4 v[72:75], v7, s[36:39], s72 offen offset:512
    buffer_load_dwordx4 v[76:79], v7, s[36:39], s72 offen offset:768
    v_mfma_f32_16x16x32_bf16 v[236:239], v[32:35], v[16:19], v[236:239]
    v_mfma_f32_16x16x32_bf16 v[252:255], v[48:51], v[16:19], v[252:255]
    v_lshl_add_u32 v2, v184, 6, v10
    buffer_load_dwordx4 v[48:51], v2, s[28:31], 0 offen
    v_add_u32 v28, 16384, v28
    v_add_u32 v29, 16384, v29
    v_add_u32 v30, 16384, v30
    v_add_u32 v31, 16384, v31
    s_add_u32 s72, s71, 8192
    s_waitcnt lgkmcnt(2)
    s_waitcnt vmcnt(15)
    s_mov_b64 vcc, s[8:9]
    v_cndmask_b32_dpp v128, v82, v80, vcc row_ror:8 row_mask:0xf bank_mask:0xf
    v_cndmask_b32_dpp v129, v83, v81, vcc row_ror:8 row_mask:0xf bank_mask:0xf
    v_cndmask_b32_dpp v130, v86, v84, vcc row_ror:8 row_mask:0xf bank_mask:0xf
    v_cndmask_b32_dpp v131, v87, v85, vcc row_ror:8 row_mask:0xf bank_mask:0xf
    v_cndmask_b32_dpp v132, v90, v88, vcc row_ror:8 row_mask:0xf bank_mask:0xf
    v_cndmask_b32_dpp v133, v91, v89, vcc row_ror:8 row_mask:0xf bank_mask:0xf
    v_cndmask_b32_dpp v134, v94, v92, vcc row_ror:8 row_mask:0xf bank_mask:0xf
    v_cndmask_b32_dpp v135, v95, v93, vcc row_ror:8 row_mask:0xf bank_mask:0xf
    s_mov_b64 vcc, s[10:11]
    v_cndmask_b32_dpp v82, v80, v82, vcc row_ror:8 row_mask:0xf bank_mask:0xf
    v_cndmask_b32_dpp v83, v81, v83, vcc row_ror:8 row_mask:0xf bank_mask:0xf
    v_cndmask_b32_dpp v86, v84, v86, vcc row_ror:8 row_mask:0xf bank_mask:0xf
    v_cndmask_b32_dpp v87, v85, v87, vcc row_ror:8 row_mask:0xf bank_mask:0xf
    v_cndmask_b32_dpp v90, v88, v90, vcc row_ror:8 row_mask:0xf bank_mask:0xf
    v_cndmask_b32_dpp v91, v89, v91, vcc row_ror:8 row_mask:0xf bank_mask:0xf
    v_cndmask_b32_dpp v94, v92, v94, vcc row_ror:8 row_mask:0xf bank_mask:0xf
    v_cndmask_b32_dpp v95, v93, v95, vcc row_ror:8 row_mask:0xf bank_mask:0xf
    v_perm_b32 v16, v130, v128, s60
    v_perm_b32 v17, v134, v132, s60
    v_perm_b32 v18, v86, v82, s60
    v_perm_b32 v19, v94, v90, s60
    v_perm_b32 v20, v130, v128, s61
    v_perm_b32 v21, v134, v132, s61
    v_perm_b32 v22, v86, v82, s61
    v_perm_b32 v23, v94, v90, s61
    v_mfma_f32_16x16x32_bf16 v[224:227], v[36:39], v[16:19], v[224:227]
    v_mfma_f32_16x16x32_bf16 v[240:243], v[52:55], v[16:19], v[240:243]
    v_perm_b32 v24, v131, v129, s60
    v_perm_b32 v25, v135, v133, s60
    v_perm_b32 v26, v87, v83, s60
    v_perm_b32 v27, v95, v91, s60
    v_mfma_f32_16x16x32_bf16 v[228:231], v[36:39], v[20:23], v[228:231]
    v_mfma_f32_16x16x32_bf16 v[244:247], v[52:55], v[20:23], v[244:247]
    v_perm_b32 v16, v131, v129, s61
    v_perm_b32 v17, v135, v133, s61
    v_perm_b32 v18, v87, v83, s61
    v_perm_b32 v19, v95, v91, s61
    v_mfma_f32_16x16x32_bf16 v[232:235], v[36:39], v[24:27], v[232:235]
    v_mfma_f32_16x16x32_bf16 v[248:251], v[52:55], v[24:27], v[248:251]
    buffer_load_dwordx4 v[80:83], v7, s[36:39], s72 offen offset:0
    buffer_load_dwordx4 v[84:87], v7, s[36:39], s72 offen offset:256
    buffer_load_dwordx4 v[88:91], v7, s[36:39], s72 offen offset:512
    buffer_load_dwordx4 v[92:95], v7, s[36:39], s72 offen offset:768
    v_mfma_f32_16x16x32_bf16 v[236:239], v[36:39], v[16:19], v[236:239]
    v_mfma_f32_16x16x32_bf16 v[252:255], v[52:55], v[16:19], v[252:255]
    v_lshl_add_u32 v2, v185, 6, v10
    buffer_load_dwordx4 v[52:55], v2, s[28:31], 0 offen
    s_add_u32 s72, s71, 16384
    s_waitcnt lgkmcnt(1)
    s_waitcnt vmcnt(15)
    s_mov_b64 vcc, s[8:9]
    v_cndmask_b32_dpp v128, v98, v96, vcc row_ror:8 row_mask:0xf bank_mask:0xf
    v_cndmask_b32_dpp v129, v99, v97, vcc row_ror:8 row_mask:0xf bank_mask:0xf
    v_cndmask_b32_dpp v130, v102, v100, vcc row_ror:8 row_mask:0xf bank_mask:0xf
    v_cndmask_b32_dpp v131, v103, v101, vcc row_ror:8 row_mask:0xf bank_mask:0xf
    v_cndmask_b32_dpp v132, v106, v104, vcc row_ror:8 row_mask:0xf bank_mask:0xf
    v_cndmask_b32_dpp v133, v107, v105, vcc row_ror:8 row_mask:0xf bank_mask:0xf
    v_cndmask_b32_dpp v134, v110, v108, vcc row_ror:8 row_mask:0xf bank_mask:0xf
    v_cndmask_b32_dpp v135, v111, v109, vcc row_ror:8 row_mask:0xf bank_mask:0xf
    s_mov_b64 vcc, s[10:11]
    v_cndmask_b32_dpp v98, v96, v98, vcc row_ror:8 row_mask:0xf bank_mask:0xf
    v_cndmask_b32_dpp v99, v97, v99, vcc row_ror:8 row_mask:0xf bank_mask:0xf
    v_cndmask_b32_dpp v102, v100, v102, vcc row_ror:8 row_mask:0xf bank_mask:0xf
    v_cndmask_b32_dpp v103, v101, v103, vcc row_ror:8 row_mask:0xf bank_mask:0xf
    v_cndmask_b32_dpp v106, v104, v106, vcc row_ror:8 row_mask:0xf bank_mask:0xf
    v_cndmask_b32_dpp v107, v105, v107, vcc row_ror:8 row_mask:0xf bank_mask:0xf
    v_cndmask_b32_dpp v110, v108, v110, vcc row_ror:8 row_mask:0xf bank_mask:0xf
    v_cndmask_b32_dpp v111, v109, v111, vcc row_ror:8 row_mask:0xf bank_mask:0xf
    v_perm_b32 v16, v130, v128, s60
    v_perm_b32 v17, v134, v132, s60
    v_perm_b32 v18, v102, v98, s60
    v_perm_b32 v19, v110, v106, s60
    v_perm_b32 v20, v130, v128, s61
    v_perm_b32 v21, v134, v132, s61
    v_perm_b32 v22, v102, v98, s61
    v_perm_b32 v23, v110, v106, s61
    v_mfma_f32_16x16x32_bf16 v[224:227], v[40:43], v[16:19], v[224:227]
    v_mfma_f32_16x16x32_bf16 v[240:243], v[56:59], v[16:19], v[240:243]
    v_perm_b32 v24, v131, v129, s60
    v_perm_b32 v25, v135, v133, s60
    v_perm_b32 v26, v103, v99, s60
    v_perm_b32 v27, v111, v107, s60
    v_mfma_f32_16x16x32_bf16 v[228:231], v[40:43], v[20:23], v[228:231]
    v_mfma_f32_16x16x32_bf16 v[244:247], v[56:59], v[20:23], v[244:247]
    v_perm_b32 v16, v131, v129, s61
    v_perm_b32 v17, v135, v133, s61
    v_perm_b32 v18, v103, v99, s61
    v_perm_b32 v19, v111, v107, s61
    v_mfma_f32_16x16x32_bf16 v[232:235], v[40:43], v[24:27], v[232:235]
    v_mfma_f32_16x16x32_bf16 v[248:251], v[56:59], v[24:27], v[248:251]
    buffer_load_dwordx4 v[96:99], v7, s[36:39], s72 offen offset:0
    buffer_load_dwordx4 v[100:103], v7, s[36:39], s72 offen offset:256
    buffer_load_dwordx4 v[104:107], v7, s[36:39], s72 offen offset:512
    buffer_load_dwordx4 v[108:111], v7, s[36:39], s72 offen offset:768
    v_mfma_f32_16x16x32_bf16 v[236:239], v[40:43], v[16:19], v[236:239]
    v_mfma_f32_16x16x32_bf16 v[252:255], v[56:59], v[16:19], v[252:255]
    v_lshl_add_u32 v2, v186, 6, v10
    buffer_load_dwordx4 v[56:59], v2, s[28:31], 0 offen
    s_add_u32 s72, s71, 24576
    s_waitcnt lgkmcnt(0)
    s_waitcnt vmcnt(15)
    s_mov_b64 vcc, s[8:9]
    v_cndmask_b32_dpp v128, v114, v112, vcc row_ror:8 row_mask:0xf bank_mask:0xf
    v_cndmask_b32_dpp v129, v115, v113, vcc row_ror:8 row_mask:0xf bank_mask:0xf
    v_cndmask_b32_dpp v130, v118, v116, vcc row_ror:8 row_mask:0xf bank_mask:0xf
    v_cndmask_b32_dpp v131, v119, v117, vcc row_ror:8 row_mask:0xf bank_mask:0xf
    v_cndmask_b32_dpp v132, v122, v120, vcc row_ror:8 row_mask:0xf bank_mask:0xf
    v_cndmask_b32_dpp v133, v123, v121, vcc row_ror:8 row_mask:0xf bank_mask:0xf
    v_cndmask_b32_dpp v134, v126, v124, vcc row_ror:8 row_mask:0xf bank_mask:0xf
    v_cndmask_b32_dpp v135, v127, v125, vcc row_ror:8 row_mask:0xf bank_mask:0xf
    s_mov_b64 vcc, s[10:11]
    v_cndmask_b32_dpp v114, v112, v114, vcc row_ror:8 row_mask:0xf bank_mask:0xf
    v_cndmask_b32_dpp v115, v113, v115, vcc row_ror:8 row_mask:0xf bank_mask:0xf
    v_cndmask_b32_dpp v118, v116, v118, vcc row_ror:8 row_mask:0xf bank_mask:0xf
    v_cndmask_b32_dpp v119, v117, v119, vcc row_ror:8 row_mask:0xf bank_mask:0xf
    v_cndmask_b32_dpp v122, v120, v122, vcc row_ror:8 row_mask:0xf bank_mask:0xf
    v_cndmask_b32_dpp v123, v121, v123, vcc row_ror:8 row_mask:0xf bank_mask:0xf
    v_cndmask_b32_dpp v126, v124, v126, vcc row_ror:8 row_mask:0xf bank_mask:0xf
    v_cndmask_b32_dpp v127, v125, v127, vcc row_ror:8 row_mask:0xf bank_mask:0xf
    v_perm_b32 v16, v130, v128, s60
    v_perm_b32 v17, v134, v132, s60
    v_perm_b32 v18, v118, v114, s60
    v_perm_b32 v19, v126, v122, s60
    v_perm_b32 v20, v130, v128, s61
    v_perm_b32 v21, v134, v132, s61
    v_perm_b32 v22, v118, v114, s61
    v_perm_b32 v23, v126, v122, s61
    v_mfma_f32_16x16x32_bf16 v[224:227], v[44:47], v[16:19], v[224:227]
    v_mfma_f32_16x16x32_bf16 v[240:243], v[60:63], v[16:19], v[240:243]
    v_perm_b32 v24, v131, v129, s60
    v_perm_b32 v25, v135, v133, s60
    v_perm_b32 v26, v119, v115, s60
    v_perm_b32 v27, v127, v123, s60
    v_mfma_f32_16x16x32_bf16 v[228:231], v[44:47], v[20:23], v[228:231]
    v_mfma_f32_16x16x32_bf16 v[244:247], v[60:63], v[20:23], v[244:247]
    v_perm_b32 v16, v131, v129, s61
    v_perm_b32 v17, v135, v133, s61
    v_perm_b32 v18, v119, v115, s61
    v_perm_b32 v19, v127, v123, s61
    v_mfma_f32_16x16x32_bf16 v[232:235], v[44:47], v[24:27], v[232:235]
    v_mfma_f32_16x16x32_bf16 v[248:251], v[60:63], v[24:27], v[248:251]
    buffer_load_dwordx4 v[112:115], v7, s[36:39], s72 offen offset:0
    buffer_load_dwordx4 v[116:119], v7, s[36:39], s72 offen offset:256
    buffer_load_dwordx4 v[120:123], v7, s[36:39], s72 offen offset:512
    buffer_load_dwordx4 v[124:127], v7, s[36:39], s72 offen offset:768
    v_mfma_f32_16x16x32_bf16 v[236:239], v[44:47], v[16:19], v[236:239]
    v_mfma_f32_16x16x32_bf16 v[252:255], v[60:63], v[16:19], v[252:255]
    v_lshl_add_u32 v2, v187, 6, v10
    buffer_load_dwordx4 v[60:63], v2, s[28:31], 0 offen
    s_add_u32 s71, s71, 131072
    s_cmp_eq_u32 s71, 786432
    s_cselect_b32 s71, 0, s71
    s_barrier
    ds_read_b128 v[32:35], v28
    ds_read_b128 v[36:39], v29
    ds_read_b128 v[40:43], v30
    ds_read_b128 v[44:47], v31
    s_add_u32 s72, s71, 0
    s_waitcnt lgkmcnt(3)
    s_waitcnt vmcnt(15)
    s_mov_b64 vcc, s[8:9]
    v_cndmask_b32_dpp v128, v66, v64, vcc row_ror:8 row_mask:0xf bank_mask:0xf
    v_cndmask_b32_dpp v129, v67, v65, vcc row_ror:8 row_mask:0xf bank_mask:0xf
    v_cndmask_b32_dpp v130, v70, v68, vcc row_ror:8 row_mask:0xf bank_mask:0xf
    v_cndmask_b32_dpp v131, v71, v69, vcc row_ror:8 row_mask:0xf bank_mask:0xf
    v_cndmask_b32_dpp v132, v74, v72, vcc row_ror:8 row_mask:0xf bank_mask:0xf
    v_cndmask_b32_dpp v133, v75, v73, vcc row_ror:8 row_mask:0xf bank_mask:0xf
    v_cndmask_b32_dpp v134, v78, v76, vcc row_ror:8 row_mask:0xf bank_mask:0xf
    v_cndmask_b32_dpp v135, v79, v77, vcc row_ror:8 row_mask:0xf bank_mask:0xf
    s_mov_b64 vcc, s[10:11]
    v_cndmask_b32_dpp v66, v64, v66, vcc row_ror:8 row_mask:0xf bank_mask:0xf
    v_cndmask_b32_dpp v67, v65, v67, vcc row_ror:8 row_mask:0xf bank_mask:0xf
    v_cndmask_b32_dpp v70, v68, v70, vcc row_ror:8 row_mask:0xf bank_mask:0xf
    v_cndmask_b32_dpp v71, v69, v71, vcc row_ror:8 row_mask:0xf bank_mask:0xf
    v_cndmask_b32_dpp v74, v72, v74, vcc row_ror:8 row_mask:0xf bank_mask:0xf
    v_cndmask_b32_dpp v75, v73, v75, vcc row_ror:8 row_mask:0xf bank_mask:0xf
    v_cndmask_b32_dpp v78, v76, v78, vcc row_ror:8 row_mask:0xf bank_mask:0xf
    v_cndmask_b32_dpp v79, v77, v79, vcc row_ror:8 row_mask:0xf bank_mask:0xf
    v_perm_b32 v16, v130, v128, s60
    v_perm_b32 v17, v134, v132, s60
    v_perm_b32 v18, v70, v66, s60
    v_perm_b32 v19, v78, v74, s60
    v_perm_b32 v20, v130, v128, s61
    v_perm_b32 v21, v134, v132, s61
    v_perm_b32 v22, v70, v66, s61
    v_perm_b32 v23, v78, v74, s61
    v_mfma_f32_16x16x32_bf16 v[224:227], v[32:35], v[16:19], v[224:227]
    v_mfma_f32_16x16x32_bf16 v[240:243], v[48:51], v[16:19], v[240:243]
    v_perm_b32 v24, v131, v129, s60
    v_perm_b32 v25, v135, v133, s60
    v_perm_b32 v26, v71, v67, s60
    v_perm_b32 v27, v79, v75, s60
    v_mfma_f32_16x16x32_bf16 v[228:231], v[32:35], v[20:23], v[228:231]
    v_mfma_f32_16x16x32_bf16 v[244:247], v[48:51], v[20:23], v[244:247]
    v_perm_b32 v16, v131, v129, s61
    v_perm_b32 v17, v135, v133, s61
    v_perm_b32 v18, v71, v67, s61
    v_perm_b32 v19, v79, v75, s61
    v_mfma_f32_16x16x32_bf16 v[232:235], v[32:35], v[24:27], v[232:235]
    v_mfma_f32_16x16x32_bf16 v[248:251], v[48:51], v[24:27], v[248:251]
    buffer_load_dwordx4 v[64:67], v7, s[36:39], s72 offen offset:0
    buffer_load_dwordx4 v[68:71], v7, s[36:39], s72 offen offset:256
    buffer_load_dwordx4 v[72:75], v7, s[36:39], s72 offen offset:512
    buffer_load_dwordx4 v[76:79], v7, s[36:39], s72 offen offset:768
    v_mfma_f32_16x16x32_bf16 v[236:239], v[32:35], v[16:19], v[236:239]
    v_mfma_f32_16x16x32_bf16 v[252:255], v[48:51], v[16:19], v[252:255]
    v_lshl_add_u32 v2, v188, 6, v10
    buffer_load_dwordx4 v[48:51], v2, s[28:31], 0 offen
    v_add_u32 v28, 16384, v28
    v_add_u32 v29, 16384, v29
    v_add_u32 v30, 16384, v30
    v_add_u32 v31, 16384, v31
    s_add_u32 s72, s71, 8192
    s_waitcnt lgkmcnt(2)
    s_waitcnt vmcnt(15)
    s_mov_b64 vcc, s[8:9]
    v_cndmask_b32_dpp v128, v82, v80, vcc row_ror:8 row_mask:0xf bank_mask:0xf
    v_cndmask_b32_dpp v129, v83, v81, vcc row_ror:8 row_mask:0xf bank_mask:0xf
    v_cndmask_b32_dpp v130, v86, v84, vcc row_ror:8 row_mask:0xf bank_mask:0xf
    v_cndmask_b32_dpp v131, v87, v85, vcc row_ror:8 row_mask:0xf bank_mask:0xf
    v_cndmask_b32_dpp v132, v90, v88, vcc row_ror:8 row_mask:0xf bank_mask:0xf
    v_cndmask_b32_dpp v133, v91, v89, vcc row_ror:8 row_mask:0xf bank_mask:0xf
    v_cndmask_b32_dpp v134, v94, v92, vcc row_ror:8 row_mask:0xf bank_mask:0xf
    v_cndmask_b32_dpp v135, v95, v93, vcc row_ror:8 row_mask:0xf bank_mask:0xf
    s_mov_b64 vcc, s[10:11]
    v_cndmask_b32_dpp v82, v80, v82, vcc row_ror:8 row_mask:0xf bank_mask:0xf
    v_cndmask_b32_dpp v83, v81, v83, vcc row_ror:8 row_mask:0xf bank_mask:0xf
    v_cndmask_b32_dpp v86, v84, v86, vcc row_ror:8 row_mask:0xf bank_mask:0xf
    v_cndmask_b32_dpp v87, v85, v87, vcc row_ror:8 row_mask:0xf bank_mask:0xf
    v_cndmask_b32_dpp v90, v88, v90, vcc row_ror:8 row_mask:0xf bank_mask:0xf
    v_cndmask_b32_dpp v91, v89, v91, vcc row_ror:8 row_mask:0xf bank_mask:0xf
    v_cndmask_b32_dpp v94, v92, v94, vcc row_ror:8 row_mask:0xf bank_mask:0xf
    v_cndmask_b32_dpp v95, v93, v95, vcc row_ror:8 row_mask:0xf bank_mask:0xf
    v_perm_b32 v16, v130, v128, s60
    v_perm_b32 v17, v134, v132, s60
    v_perm_b32 v18, v86, v82, s60
    v_perm_b32 v19, v94, v90, s60
    v_perm_b32 v20, v130, v128, s61
    v_perm_b32 v21, v134, v132, s61
    v_perm_b32 v22, v86, v82, s61
    v_perm_b32 v23, v94, v90, s61
    v_mfma_f32_16x16x32_bf16 v[224:227], v[36:39], v[16:19], v[224:227]
    v_mfma_f32_16x16x32_bf16 v[240:243], v[52:55], v[16:19], v[240:243]
    v_perm_b32 v24, v131, v129, s60
    v_perm_b32 v25, v135, v133, s60
    v_perm_b32 v26, v87, v83, s60
    v_perm_b32 v27, v95, v91, s60
    v_mfma_f32_16x16x32_bf16 v[228:231], v[36:39], v[20:23], v[228:231]
    v_mfma_f32_16x16x32_bf16 v[244:247], v[52:55], v[20:23], v[244:247]
    v_perm_b32 v16, v131, v129, s61
    v_perm_b32 v17, v135, v133, s61
    v_perm_b32 v18, v87, v83, s61
    v_perm_b32 v19, v95, v91, s61
    v_mfma_f32_16x16x32_bf16 v[232:235], v[36:39], v[24:27], v[232:235]
    v_mfma_f32_16x16x32_bf16 v[248:251], v[52:55], v[24:27], v[248:251]
    buffer_load_dwordx4 v[80:83], v7, s[36:39], s72 offen offset:0
    buffer_load_dwordx4 v[84:87], v7, s[36:39], s72 offen offset:256
    buffer_load_dwordx4 v[88:91], v7, s[36:39], s72 offen offset:512
    buffer_load_dwordx4 v[92:95], v7, s[36:39], s72 offen offset:768
    v_mfma_f32_16x16x32_bf16 v[236:239], v[36:39], v[16:19], v[236:239]
    v_mfma_f32_16x16x32_bf16 v[252:255], v[52:55], v[16:19], v[252:255]
    v_lshl_add_u32 v2, v189, 6, v10
    buffer_load_dwordx4 v[52:55], v2, s[28:31], 0 offen
    s_add_u32 s72, s71, 16384
    s_waitcnt lgkmcnt(1)
    s_waitcnt vmcnt(15)
    s_mov_b64 vcc, s[8:9]
    v_cndmask_b32_dpp v128, v98, v96, vcc row_ror:8 row_mask:0xf bank_mask:0xf
    v_cndmask_b32_dpp v129, v99, v97, vcc row_ror:8 row_mask:0xf bank_mask:0xf
    v_cndmask_b32_dpp v130, v102, v100, vcc row_ror:8 row_mask:0xf bank_mask:0xf
    v_cndmask_b32_dpp v131, v103, v101, vcc row_ror:8 row_mask:0xf bank_mask:0xf
    v_cndmask_b32_dpp v132, v106, v104, vcc row_ror:8 row_mask:0xf bank_mask:0xf
    v_cndmask_b32_dpp v133, v107, v105, vcc row_ror:8 row_mask:0xf bank_mask:0xf
    v_cndmask_b32_dpp v134, v110, v108, vcc row_ror:8 row_mask:0xf bank_mask:0xf
    v_cndmask_b32_dpp v135, v111, v109, vcc row_ror:8 row_mask:0xf bank_mask:0xf
    s_mov_b64 vcc, s[10:11]
    v_cndmask_b32_dpp v98, v96, v98, vcc row_ror:8 row_mask:0xf bank_mask:0xf
    v_cndmask_b32_dpp v99, v97, v99, vcc row_ror:8 row_mask:0xf bank_mask:0xf
    v_cndmask_b32_dpp v102, v100, v102, vcc row_ror:8 row_mask:0xf bank_mask:0xf
    v_cndmask_b32_dpp v103, v101, v103, vcc row_ror:8 row_mask:0xf bank_mask:0xf
    v_cndmask_b32_dpp v106, v104, v106, vcc row_ror:8 row_mask:0xf bank_mask:0xf
    v_cndmask_b32_dpp v107, v105, v107, vcc row_ror:8 row_mask:0xf bank_mask:0xf
    v_cndmask_b32_dpp v110, v108, v110, vcc row_ror:8 row_mask:0xf bank_mask:0xf
    v_cndmask_b32_dpp v111, v109, v111, vcc row_ror:8 row_mask:0xf bank_mask:0xf
    v_perm_b32 v16, v130, v128, s60
    v_perm_b32 v17, v134, v132, s60
    v_perm_b32 v18, v102, v98, s60
    v_perm_b32 v19, v110, v106, s60
    v_perm_b32 v20, v130, v128, s61
    v_perm_b32 v21, v134, v132, s61
    v_perm_b32 v22, v102, v98, s61
    v_perm_b32 v23, v110, v106, s61
    v_mfma_f32_16x16x32_bf16 v[224:227], v[40:43], v[16:19], v[224:227]
    v_mfma_f32_16x16x32_bf16 v[240:243], v[56:59], v[16:19], v[240:243]
    v_perm_b32 v24, v131, v129, s60
    v_perm_b32 v25, v135, v133, s60
    v_perm_b32 v26, v103, v99, s60
    v_perm_b32 v27, v111, v107, s60
    v_mfma_f32_16x16x32_bf16 v[228:231], v[40:43], v[20:23], v[228:231]
    v_mfma_f32_16x16x32_bf16 v[244:247], v[56:59], v[20:23], v[244:247]
    v_perm_b32 v16, v131, v129, s61
    v_perm_b32 v17, v135, v133, s61
    v_perm_b32 v18, v103, v99, s61
    v_perm_b32 v19, v111, v107, s61
    v_mfma_f32_16x16x32_bf16 v[232:235], v[40:43], v[24:27], v[232:235]
    v_mfma_f32_16x16x32_bf16 v[248:251], v[56:59], v[24:27], v[248:251]
    buffer_load_dwordx4 v[96:99], v7, s[36:39], s72 offen offset:0
    buffer_load_dwordx4 v[100:103], v7, s[36:39], s72 offen offset:256
    buffer_load_dwordx4 v[104:107], v7, s[36:39], s72 offen offset:512
    buffer_load_dwordx4 v[108:111], v7, s[36:39], s72 offen offset:768
    v_mfma_f32_16x16x32_bf16 v[236:239], v[40:43], v[16:19], v[236:239]
    v_mfma_f32_16x16x32_bf16 v[252:255], v[56:59], v[16:19], v[252:255]
    v_lshl_add_u32 v2, v190, 6, v10
    buffer_load_dwordx4 v[56:59], v2, s[28:31], 0 offen
    s_add_u32 s72, s71, 24576
    s_waitcnt lgkmcnt(0)
    s_waitcnt vmcnt(15)
    s_mov_b64 vcc, s[8:9]
    v_cndmask_b32_dpp v128, v114, v112, vcc row_ror:8 row_mask:0xf bank_mask:0xf
    v_cndmask_b32_dpp v129, v115, v113, vcc row_ror:8 row_mask:0xf bank_mask:0xf
    v_cndmask_b32_dpp v130, v118, v116, vcc row_ror:8 row_mask:0xf bank_mask:0xf
    v_cndmask_b32_dpp v131, v119, v117, vcc row_ror:8 row_mask:0xf bank_mask:0xf
    v_cndmask_b32_dpp v132, v122, v120, vcc row_ror:8 row_mask:0xf bank_mask:0xf
    v_cndmask_b32_dpp v133, v123, v121, vcc row_ror:8 row_mask:0xf bank_mask:0xf
    v_cndmask_b32_dpp v134, v126, v124, vcc row_ror:8 row_mask:0xf bank_mask:0xf
    v_cndmask_b32_dpp v135, v127, v125, vcc row_ror:8 row_mask:0xf bank_mask:0xf
    s_mov_b64 vcc, s[10:11]
    v_cndmask_b32_dpp v114, v112, v114, vcc row_ror:8 row_mask:0xf bank_mask:0xf
    v_cndmask_b32_dpp v115, v113, v115, vcc row_ror:8 row_mask:0xf bank_mask:0xf
    v_cndmask_b32_dpp v118, v116, v118, vcc row_ror:8 row_mask:0xf bank_mask:0xf
    v_cndmask_b32_dpp v119, v117, v119, vcc row_ror:8 row_mask:0xf bank_mask:0xf
    v_cndmask_b32_dpp v122, v120, v122, vcc row_ror:8 row_mask:0xf bank_mask:0xf
    v_cndmask_b32_dpp v123, v121, v123, vcc row_ror:8 row_mask:0xf bank_mask:0xf
    v_cndmask_b32_dpp v126, v124, v126, vcc row_ror:8 row_mask:0xf bank_mask:0xf
    v_cndmask_b32_dpp v127, v125, v127, vcc row_ror:8 row_mask:0xf bank_mask:0xf
    v_perm_b32 v16, v130, v128, s60
    v_perm_b32 v17, v134, v132, s60
    v_perm_b32 v18, v118, v114, s60
    v_perm_b32 v19, v126, v122, s60
    v_perm_b32 v20, v130, v128, s61
    v_perm_b32 v21, v134, v132, s61
    v_perm_b32 v22, v118, v114, s61
    v_perm_b32 v23, v126, v122, s61
    v_mfma_f32_16x16x32_bf16 v[224:227], v[44:47], v[16:19], v[224:227]
    v_mfma_f32_16x16x32_bf16 v[240:243], v[60:63], v[16:19], v[240:243]
    v_perm_b32 v24, v131, v129, s60
    v_perm_b32 v25, v135, v133, s60
    v_perm_b32 v26, v119, v115, s60
    v_perm_b32 v27, v127, v123, s60
    v_mfma_f32_16x16x32_bf16 v[228:231], v[44:47], v[20:23], v[228:231]
    v_mfma_f32_16x16x32_bf16 v[244:247], v[60:63], v[20:23], v[244:247]
    v_perm_b32 v16, v131, v129, s61
    v_perm_b32 v17, v135, v133, s61
    v_perm_b32 v18, v119, v115, s61
    v_perm_b32 v19, v127, v123, s61
    v_mfma_f32_16x16x32_bf16 v[232:235], v[44:47], v[24:27], v[232:235]
    v_mfma_f32_16x16x32_bf16 v[248:251], v[60:63], v[24:27], v[248:251]
    buffer_load_dwordx4 v[112:115], v7, s[36:39], s72 offen offset:0
    buffer_load_dwordx4 v[116:119], v7, s[36:39], s72 offen offset:256
    buffer_load_dwordx4 v[120:123], v7, s[36:39], s72 offen offset:512
    buffer_load_dwordx4 v[124:127], v7, s[36:39], s72 offen offset:768
    v_mfma_f32_16x16x32_bf16 v[236:239], v[44:47], v[16:19], v[236:239]
    v_mfma_f32_16x16x32_bf16 v[252:255], v[60:63], v[16:19], v[252:255]
    v_lshl_add_u32 v2, v191, 6, v10
    buffer_load_dwordx4 v[60:63], v2, s[28:31], 0 offen
    s_add_u32 s71, s71, 131072
    s_cmp_eq_u32 s71, 786432
    s_cselect_b32 s71, 0, s71
    s_barrier
    ds_read_b128 v[32:35], v28
    ds_read_b128 v[36:39], v29
    ds_read_b128 v[40:43], v30
    ds_read_b128 v[44:47], v31
    s_add_u32 s72, s71, 0
    s_waitcnt lgkmcnt(3)
    s_waitcnt vmcnt(15)
    s_mov_b64 vcc, s[8:9]
    v_cndmask_b32_dpp v128, v66, v64, vcc row_ror:8 row_mask:0xf bank_mask:0xf
    v_cndmask_b32_dpp v129, v67, v65, vcc row_ror:8 row_mask:0xf bank_mask:0xf
    v_cndmask_b32_dpp v130, v70, v68, vcc row_ror:8 row_mask:0xf bank_mask:0xf
    v_cndmask_b32_dpp v131, v71, v69, vcc row_ror:8 row_mask:0xf bank_mask:0xf
    v_cndmask_b32_dpp v132, v74, v72, vcc row_ror:8 row_mask:0xf bank_mask:0xf
    v_cndmask_b32_dpp v133, v75, v73, vcc row_ror:8 row_mask:0xf bank_mask:0xf
    v_cndmask_b32_dpp v134, v78, v76, vcc row_ror:8 row_mask:0xf bank_mask:0xf
    v_cndmask_b32_dpp v135, v79, v77, vcc row_ror:8 row_mask:0xf bank_mask:0xf
    s_mov_b64 vcc, s[10:11]
    v_cndmask_b32_dpp v66, v64, v66, vcc row_ror:8 row_mask:0xf bank_mask:0xf
    v_cndmask_b32_dpp v67, v65, v67, vcc row_ror:8 row_mask:0xf bank_mask:0xf
    v_cndmask_b32_dpp v70, v68, v70, vcc row_ror:8 row_mask:0xf bank_mask:0xf
    v_cndmask_b32_dpp v71, v69, v71, vcc row_ror:8 row_mask:0xf bank_mask:0xf
    v_cndmask_b32_dpp v74, v72, v74, vcc row_ror:8 row_mask:0xf bank_mask:0xf
    v_cndmask_b32_dpp v75, v73, v75, vcc row_ror:8 row_mask:0xf bank_mask:0xf
    v_cndmask_b32_dpp v78, v76, v78, vcc row_ror:8 row_mask:0xf bank_mask:0xf
    v_cndmask_b32_dpp v79, v77, v79, vcc row_ror:8 row_mask:0xf bank_mask:0xf
    v_perm_b32 v16, v130, v128, s60
    v_perm_b32 v17, v134, v132, s60
    v_perm_b32 v18, v70, v66, s60
    v_perm_b32 v19, v78, v74, s60
    v_perm_b32 v20, v130, v128, s61
    v_perm_b32 v21, v134, v132, s61
    v_perm_b32 v22, v70, v66, s61
    v_perm_b32 v23, v78, v74, s61
    v_mfma_f32_16x16x32_bf16 v[224:227], v[32:35], v[16:19], v[224:227]
    v_mfma_f32_16x16x32_bf16 v[240:243], v[48:51], v[16:19], v[240:243]
    v_perm_b32 v24, v131, v129, s60
    v_perm_b32 v25, v135, v133, s60
    v_perm_b32 v26, v71, v67, s60
    v_perm_b32 v27, v79, v75, s60
    v_mfma_f32_16x16x32_bf16 v[228:231], v[32:35], v[20:23], v[228:231]
    v_mfma_f32_16x16x32_bf16 v[244:247], v[48:51], v[20:23], v[244:247]
    v_perm_b32 v16, v131, v129, s61
    v_perm_b32 v17, v135, v133, s61
    v_perm_b32 v18, v71, v67, s61
    v_perm_b32 v19, v79, v75, s61
    v_mfma_f32_16x16x32_bf16 v[232:235], v[32:35], v[24:27], v[232:235]
    v_mfma_f32_16x16x32_bf16 v[248:251], v[48:51], v[24:27], v[248:251]
    buffer_load_dwordx4 v[64:67], v7, s[36:39], s72 offen offset:0
    buffer_load_dwordx4 v[68:71], v7, s[36:39], s72 offen offset:256
    buffer_load_dwordx4 v[72:75], v7, s[36:39], s72 offen offset:512
    buffer_load_dwordx4 v[76:79], v7, s[36:39], s72 offen offset:768
    v_mfma_f32_16x16x32_bf16 v[236:239], v[32:35], v[16:19], v[236:239]
    v_mfma_f32_16x16x32_bf16 v[252:255], v[48:51], v[16:19], v[252:255]
    v_lshl_add_u32 v2, v192, 6, v10
    buffer_load_dwordx4 v[48:51], v2, s[28:31], 0 offen
    v_add_u32 v28, 16384, v28
    v_add_u32 v29, 16384, v29
    v_add_u32 v30, 16384, v30
    v_add_u32 v31, 16384, v31
    s_add_u32 s72, s71, 8192
    s_waitcnt lgkmcnt(2)
    s_waitcnt vmcnt(15)
    s_mov_b64 vcc, s[8:9]
    v_cndmask_b32_dpp v128, v82, v80, vcc row_ror:8 row_mask:0xf bank_mask:0xf
    v_cndmask_b32_dpp v129, v83, v81, vcc row_ror:8 row_mask:0xf bank_mask:0xf
    v_cndmask_b32_dpp v130, v86, v84, vcc row_ror:8 row_mask:0xf bank_mask:0xf
    v_cndmask_b32_dpp v131, v87, v85, vcc row_ror:8 row_mask:0xf bank_mask:0xf
    v_cndmask_b32_dpp v132, v90, v88, vcc row_ror:8 row_mask:0xf bank_mask:0xf
    v_cndmask_b32_dpp v133, v91, v89, vcc row_ror:8 row_mask:0xf bank_mask:0xf
    v_cndmask_b32_dpp v134, v94, v92, vcc row_ror:8 row_mask:0xf bank_mask:0xf
    v_cndmask_b32_dpp v135, v95, v93, vcc row_ror:8 row_mask:0xf bank_mask:0xf
    s_mov_b64 vcc, s[10:11]
    v_cndmask_b32_dpp v82, v80, v82, vcc row_ror:8 row_mask:0xf bank_mask:0xf
    v_cndmask_b32_dpp v83, v81, v83, vcc row_ror:8 row_mask:0xf bank_mask:0xf
    v_cndmask_b32_dpp v86, v84, v86, vcc row_ror:8 row_mask:0xf bank_mask:0xf
    v_cndmask_b32_dpp v87, v85, v87, vcc row_ror:8 row_mask:0xf bank_mask:0xf
    v_cndmask_b32_dpp v90, v88, v90, vcc row_ror:8 row_mask:0xf bank_mask:0xf
    v_cndmask_b32_dpp v91, v89, v91, vcc row_ror:8 row_mask:0xf bank_mask:0xf
    v_cndmask_b32_dpp v94, v92, v94, vcc row_ror:8 row_mask:0xf bank_mask:0xf
    v_cndmask_b32_dpp v95, v93, v95, vcc row_ror:8 row_mask:0xf bank_mask:0xf
    v_perm_b32 v16, v130, v128, s60
    v_perm_b32 v17, v134, v132, s60
    v_perm_b32 v18, v86, v82, s60
    v_perm_b32 v19, v94, v90, s60
    v_perm_b32 v20, v130, v128, s61
    v_perm_b32 v21, v134, v132, s61
    v_perm_b32 v22, v86, v82, s61
    v_perm_b32 v23, v94, v90, s61
    v_mfma_f32_16x16x32_bf16 v[224:227], v[36:39], v[16:19], v[224:227]
    v_mfma_f32_16x16x32_bf16 v[240:243], v[52:55], v[16:19], v[240:243]
    v_perm_b32 v24, v131, v129, s60
    v_perm_b32 v25, v135, v133, s60
    v_perm_b32 v26, v87, v83, s60
    v_perm_b32 v27, v95, v91, s60
    v_mfma_f32_16x16x32_bf16 v[228:231], v[36:39], v[20:23], v[228:231]
    v_mfma_f32_16x16x32_bf16 v[244:247], v[52:55], v[20:23], v[244:247]
    v_perm_b32 v16, v131, v129, s61
    v_perm_b32 v17, v135, v133, s61
    v_perm_b32 v18, v87, v83, s61
    v_perm_b32 v19, v95, v91, s61
    v_mfma_f32_16x16x32_bf16 v[232:235], v[36:39], v[24:27], v[232:235]
    v_mfma_f32_16x16x32_bf16 v[248:251], v[52:55], v[24:27], v[248:251]
    buffer_load_dwordx4 v[80:83], v7, s[36:39], s72 offen offset:0
    buffer_load_dwordx4 v[84:87], v7, s[36:39], s72 offen offset:256
    buffer_load_dwordx4 v[88:91], v7, s[36:39], s72 offen offset:512
    buffer_load_dwordx4 v[92:95], v7, s[36:39], s72 offen offset:768
    v_mfma_f32_16x16x32_bf16 v[236:239], v[36:39], v[16:19], v[236:239]
    v_mfma_f32_16x16x32_bf16 v[252:255], v[52:55], v[16:19], v[252:255]
    v_lshl_add_u32 v2, v193, 6, v10
    buffer_load_dwordx4 v[52:55], v2, s[28:31], 0 offen
    s_add_u32 s72, s71, 16384
    s_waitcnt lgkmcnt(1)
    s_waitcnt vmcnt(15)
    s_mov_b64 vcc, s[8:9]
    v_cndmask_b32_dpp v128, v98, v96, vcc row_ror:8 row_mask:0xf bank_mask:0xf
    v_cndmask_b32_dpp v129, v99, v97, vcc row_ror:8 row_mask:0xf bank_mask:0xf
    v_cndmask_b32_dpp v130, v102, v100, vcc row_ror:8 row_mask:0xf bank_mask:0xf
    v_cndmask_b32_dpp v131, v103, v101, vcc row_ror:8 row_mask:0xf bank_mask:0xf
    v_cndmask_b32_dpp v132, v106, v104, vcc row_ror:8 row_mask:0xf bank_mask:0xf
    v_cndmask_b32_dpp v133, v107, v105, vcc row_ror:8 row_mask:0xf bank_mask:0xf
    v_cndmask_b32_dpp v134, v110, v108, vcc row_ror:8 row_mask:0xf bank_mask:0xf
    v_cndmask_b32_dpp v135, v111, v109, vcc row_ror:8 row_mask:0xf bank_mask:0xf
    s_mov_b64 vcc, s[10:11]
    v_cndmask_b32_dpp v98, v96, v98, vcc row_ror:8 row_mask:0xf bank_mask:0xf
    v_cndmask_b32_dpp v99, v97, v99, vcc row_ror:8 row_mask:0xf bank_mask:0xf
    v_cndmask_b32_dpp v102, v100, v102, vcc row_ror:8 row_mask:0xf bank_mask:0xf
    v_cndmask_b32_dpp v103, v101, v103, vcc row_ror:8 row_mask:0xf bank_mask:0xf
    v_cndmask_b32_dpp v106, v104, v106, vcc row_ror:8 row_mask:0xf bank_mask:0xf
    v_cndmask_b32_dpp v107, v105, v107, vcc row_ror:8 row_mask:0xf bank_mask:0xf
    v_cndmask_b32_dpp v110, v108, v110, vcc row_ror:8 row_mask:0xf bank_mask:0xf
    v_cndmask_b32_dpp v111, v109, v111, vcc row_ror:8 row_mask:0xf bank_mask:0xf
    v_perm_b32 v16, v130, v128, s60
    v_perm_b32 v17, v134, v132, s60
    v_perm_b32 v18, v102, v98, s60
    v_perm_b32 v19, v110, v106, s60
    v_perm_b32 v20, v130, v128, s61
    v_perm_b32 v21, v134, v132, s61
    v_perm_b32 v22, v102, v98, s61
    v_perm_b32 v23, v110, v106, s61
    v_mfma_f32_16x16x32_bf16 v[224:227], v[40:43], v[16:19], v[224:227]
    v_mfma_f32_16x16x32_bf16 v[240:243], v[56:59], v[16:19], v[240:243]
    v_perm_b32 v24, v131, v129, s60
    v_perm_b32 v25, v135, v133, s60
    v_perm_b32 v26, v103, v99, s60
    v_perm_b32 v27, v111, v107, s60
    v_mfma_f32_16x16x32_bf16 v[228:231], v[40:43], v[20:23], v[228:231]
    v_mfma_f32_16x16x32_bf16 v[244:247], v[56:59], v[20:23], v[244:247]
    v_perm_b32 v16, v131, v129, s61
    v_perm_b32 v17, v135, v133, s61
    v_perm_b32 v18, v103, v99, s61
    v_perm_b32 v19, v111, v107, s61
    v_mfma_f32_16x16x32_bf16 v[232:235], v[40:43], v[24:27], v[232:235]
    v_mfma_f32_16x16x32_bf16 v[248:251], v[56:59], v[24:27], v[248:251]
    buffer_load_dwordx4 v[96:99], v7, s[36:39], s72 offen offset:0
    buffer_load_dwordx4 v[100:103], v7, s[36:39], s72 offen offset:256
    buffer_load_dwordx4 v[104:107], v7, s[36:39], s72 offen offset:512
    buffer_load_dwordx4 v[108:111], v7, s[36:39], s72 offen offset:768
    v_mfma_f32_16x16x32_bf16 v[236:239], v[40:43], v[16:19], v[236:239]
    v_mfma_f32_16x16x32_bf16 v[252:255], v[56:59], v[16:19], v[252:255]
    v_lshl_add_u32 v2, v194, 6, v10
    buffer_load_dwordx4 v[56:59], v2, s[28:31], 0 offen
    s_add_u32 s72, s71, 24576
    s_waitcnt lgkmcnt(0)
    s_waitcnt vmcnt(15)
    s_mov_b64 vcc, s[8:9]
    v_cndmask_b32_dpp v128, v114, v112, vcc row_ror:8 row_mask:0xf bank_mask:0xf
    v_cndmask_b32_dpp v129, v115, v113, vcc row_ror:8 row_mask:0xf bank_mask:0xf
    v_cndmask_b32_dpp v130, v118, v116, vcc row_ror:8 row_mask:0xf bank_mask:0xf
    v_cndmask_b32_dpp v131, v119, v117, vcc row_ror:8 row_mask:0xf bank_mask:0xf
    v_cndmask_b32_dpp v132, v122, v120, vcc row_ror:8 row_mask:0xf bank_mask:0xf
    v_cndmask_b32_dpp v133, v123, v121, vcc row_ror:8 row_mask:0xf bank_mask:0xf
    v_cndmask_b32_dpp v134, v126, v124, vcc row_ror:8 row_mask:0xf bank_mask:0xf
    v_cndmask_b32_dpp v135, v127, v125, vcc row_ror:8 row_mask:0xf bank_mask:0xf
    s_mov_b64 vcc, s[10:11]
    v_cndmask_b32_dpp v114, v112, v114, vcc row_ror:8 row_mask:0xf bank_mask:0xf
    v_cndmask_b32_dpp v115, v113, v115, vcc row_ror:8 row_mask:0xf bank_mask:0xf
    v_cndmask_b32_dpp v118, v116, v118, vcc row_ror:8 row_mask:0xf bank_mask:0xf
    v_cndmask_b32_dpp v119, v117, v119, vcc row_ror:8 row_mask:0xf bank_mask:0xf
    v_cndmask_b32_dpp v122, v120, v122, vcc row_ror:8 row_mask:0xf bank_mask:0xf
    v_cndmask_b32_dpp v123, v121, v123, vcc row_ror:8 row_mask:0xf bank_mask:0xf
    v_cndmask_b32_dpp v126, v124, v126, vcc row_ror:8 row_mask:0xf bank_mask:0xf
    v_cndmask_b32_dpp v127, v125, v127, vcc row_ror:8 row_mask:0xf bank_mask:0xf
    v_perm_b32 v16, v130, v128, s60
    v_perm_b32 v17, v134, v132, s60
    v_perm_b32 v18, v118, v114, s60
    v_perm_b32 v19, v126, v122, s60
    v_perm_b32 v20, v130, v128, s61
    v_perm_b32 v21, v134, v132, s61
    v_perm_b32 v22, v118, v114, s61
    v_perm_b32 v23, v126, v122, s61
    v_mfma_f32_16x16x32_bf16 v[224:227], v[44:47], v[16:19], v[224:227]
    v_mfma_f32_16x16x32_bf16 v[240:243], v[60:63], v[16:19], v[240:243]
    v_perm_b32 v24, v131, v129, s60
    v_perm_b32 v25, v135, v133, s60
    v_perm_b32 v26, v119, v115, s60
    v_perm_b32 v27, v127, v123, s60
    v_mfma_f32_16x16x32_bf16 v[228:231], v[44:47], v[20:23], v[228:231]
    v_mfma_f32_16x16x32_bf16 v[244:247], v[60:63], v[20:23], v[244:247]
    v_perm_b32 v16, v131, v129, s61
    v_perm_b32 v17, v135, v133, s61
    v_perm_b32 v18, v119, v115, s61
    v_perm_b32 v19, v127, v123, s61
    v_mfma_f32_16x16x32_bf16 v[232:235], v[44:47], v[24:27], v[232:235]
    v_mfma_f32_16x16x32_bf16 v[248:251], v[60:63], v[24:27], v[248:251]
    buffer_load_dwordx4 v[112:115], v7, s[36:39], s72 offen offset:0
    buffer_load_dwordx4 v[116:119], v7, s[36:39], s72 offen offset:256
    buffer_load_dwordx4 v[120:123], v7, s[36:39], s72 offen offset:512
    buffer_load_dwordx4 v[124:127], v7, s[36:39], s72 offen offset:768
    v_mfma_f32_16x16x32_bf16 v[236:239], v[44:47], v[16:19], v[236:239]
    v_mfma_f32_16x16x32_bf16 v[252:255], v[60:63], v[16:19], v[252:255]
    v_lshl_add_u32 v2, v195, 6, v10
    buffer_load_dwordx4 v[60:63], v2, s[28:31], 0 offen
    s_add_u32 s71, s71, 131072
    s_cmp_eq_u32 s71, 786432
    s_cselect_b32 s71, 0, s71
    s_barrier
    ds_read_b128 v[32:35], v28
    ds_read_b128 v[36:39], v29
    ds_read_b128 v[40:43], v30
    ds_read_b128 v[44:47], v31
    s_add_u32 s72, s71, 0
    s_waitcnt lgkmcnt(3)
    s_waitcnt vmcnt(15)
    s_mov_b64 vcc, s[8:9]
    v_cndmask_b32_dpp v128, v66, v64, vcc row_ror:8 row_mask:0xf bank_mask:0xf
    v_cndmask_b32_dpp v129, v67, v65, vcc row_ror:8 row_mask:0xf bank_mask:0xf
    v_cndmask_b32_dpp v130, v70, v68, vcc row_ror:8 row_mask:0xf bank_mask:0xf
    v_cndmask_b32_dpp v131, v71, v69, vcc row_ror:8 row_mask:0xf bank_mask:0xf
    v_cndmask_b32_dpp v132, v74, v72, vcc row_ror:8 row_mask:0xf bank_mask:0xf
    v_cndmask_b32_dpp v133, v75, v73, vcc row_ror:8 row_mask:0xf bank_mask:0xf
    v_cndmask_b32_dpp v134, v78, v76, vcc row_ror:8 row_mask:0xf bank_mask:0xf
    v_cndmask_b32_dpp v135, v79, v77, vcc row_ror:8 row_mask:0xf bank_mask:0xf
    s_mov_b64 vcc, s[10:11]
    v_cndmask_b32_dpp v66, v64, v66, vcc row_ror:8 row_mask:0xf bank_mask:0xf
    v_cndmask_b32_dpp v67, v65, v67, vcc row_ror:8 row_mask:0xf bank_mask:0xf
    v_cndmask_b32_dpp v70, v68, v70, vcc row_ror:8 row_mask:0xf bank_mask:0xf
    v_cndmask_b32_dpp v71, v69, v71, vcc row_ror:8 row_mask:0xf bank_mask:0xf
    v_cndmask_b32_dpp v74, v72, v74, vcc row_ror:8 row_mask:0xf bank_mask:0xf
    v_cndmask_b32_dpp v75, v73, v75, vcc row_ror:8 row_mask:0xf bank_mask:0xf
    v_cndmask_b32_dpp v78, v76, v78, vcc row_ror:8 row_mask:0xf bank_mask:0xf
    v_cndmask_b32_dpp v79, v77, v79, vcc row_ror:8 row_mask:0xf bank_mask:0xf
    v_perm_b32 v16, v130, v128, s60
    v_perm_b32 v17, v134, v132, s60
    v_perm_b32 v18, v70, v66, s60
    v_perm_b32 v19, v78, v74, s60
    v_perm_b32 v20, v130, v128, s61
    v_perm_b32 v21, v134, v132, s61
    v_perm_b32 v22, v70, v66, s61
    v_perm_b32 v23, v78, v74, s61
    v_mfma_f32_16x16x32_bf16 v[224:227], v[32:35], v[16:19], v[224:227]
    v_mfma_f32_16x16x32_bf16 v[240:243], v[48:51], v[16:19], v[240:243]
    v_perm_b32 v24, v131, v129, s60
    v_perm_b32 v25, v135, v133, s60
    v_perm_b32 v26, v71, v67, s60
    v_perm_b32 v27, v79, v75, s60
    v_mfma_f32_16x16x32_bf16 v[228:231], v[32:35], v[20:23], v[228:231]
    v_mfma_f32_16x16x32_bf16 v[244:247], v[48:51], v[20:23], v[244:247]
    v_perm_b32 v16, v131, v129, s61
    v_perm_b32 v17, v135, v133, s61
    v_perm_b32 v18, v71, v67, s61
    v_perm_b32 v19, v79, v75, s61
    v_mfma_f32_16x16x32_bf16 v[232:235], v[32:35], v[24:27], v[232:235]
    v_mfma_f32_16x16x32_bf16 v[248:251], v[48:51], v[24:27], v[248:251]
    buffer_load_dwordx4 v[64:67], v7, s[36:39], s72 offen offset:0
    buffer_load_dwordx4 v[68:71], v7, s[36:39], s72 offen offset:256
    buffer_load_dwordx4 v[72:75], v7, s[36:39], s72 offen offset:512
    buffer_load_dwordx4 v[76:79], v7, s[36:39], s72 offen offset:768
    v_mfma_f32_16x16x32_bf16 v[236:239], v[32:35], v[16:19], v[236:239]
    v_mfma_f32_16x16x32_bf16 v[252:255], v[48:51], v[16:19], v[252:255]
    v_lshl_add_u32 v2, v196, 6, v10
    buffer_load_dwordx4 v[48:51], v2, s[28:31], 0 offen
    v_add_u32 v28, 16384, v28
    v_add_u32 v29, 16384, v29
    v_add_u32 v30, 16384, v30
    v_add_u32 v31, 16384, v31
    s_add_u32 s72, s71, 8192
    s_waitcnt lgkmcnt(2)
    s_waitcnt vmcnt(15)
    s_mov_b64 vcc, s[8:9]
    v_cndmask_b32_dpp v128, v82, v80, vcc row_ror:8 row_mask:0xf bank_mask:0xf
    v_cndmask_b32_dpp v129, v83, v81, vcc row_ror:8 row_mask:0xf bank_mask:0xf
    v_cndmask_b32_dpp v130, v86, v84, vcc row_ror:8 row_mask:0xf bank_mask:0xf
    v_cndmask_b32_dpp v131, v87, v85, vcc row_ror:8 row_mask:0xf bank_mask:0xf
    v_cndmask_b32_dpp v132, v90, v88, vcc row_ror:8 row_mask:0xf bank_mask:0xf
    v_cndmask_b32_dpp v133, v91, v89, vcc row_ror:8 row_mask:0xf bank_mask:0xf
    v_cndmask_b32_dpp v134, v94, v92, vcc row_ror:8 row_mask:0xf bank_mask:0xf
    v_cndmask_b32_dpp v135, v95, v93, vcc row_ror:8 row_mask:0xf bank_mask:0xf
    s_mov_b64 vcc, s[10:11]
    v_cndmask_b32_dpp v82, v80, v82, vcc row_ror:8 row_mask:0xf bank_mask:0xf
    v_cndmask_b32_dpp v83, v81, v83, vcc row_ror:8 row_mask:0xf bank_mask:0xf
    v_cndmask_b32_dpp v86, v84, v86, vcc row_ror:8 row_mask:0xf bank_mask:0xf
    v_cndmask_b32_dpp v87, v85, v87, vcc row_ror:8 row_mask:0xf bank_mask:0xf
    v_cndmask_b32_dpp v90, v88, v90, vcc row_ror:8 row_mask:0xf bank_mask:0xf
    v_cndmask_b32_dpp v91, v89, v91, vcc row_ror:8 row_mask:0xf bank_mask:0xf
    v_cndmask_b32_dpp v94, v92, v94, vcc row_ror:8 row_mask:0xf bank_mask:0xf
    v_cndmask_b32_dpp v95, v93, v95, vcc row_ror:8 row_mask:0xf bank_mask:0xf
    v_perm_b32 v16, v130, v128, s60
    v_perm_b32 v17, v134, v132, s60
    v_perm_b32 v18, v86, v82, s60
    v_perm_b32 v19, v94, v90, s60
    v_perm_b32 v20, v130, v128, s61
    v_perm_b32 v21, v134, v132, s61
    v_perm_b32 v22, v86, v82, s61
    v_perm_b32 v23, v94, v90, s61
    v_mfma_f32_16x16x32_bf16 v[224:227], v[36:39], v[16:19], v[224:227]
    v_mfma_f32_16x16x32_bf16 v[240:243], v[52:55], v[16:19], v[240:243]
    v_perm_b32 v24, v131, v129, s60
    v_perm_b32 v25, v135, v133, s60
    v_perm_b32 v26, v87, v83, s60
    v_perm_b32 v27, v95, v91, s60
    v_mfma_f32_16x16x32_bf16 v[228:231], v[36:39], v[20:23], v[228:231]
    v_mfma_f32_16x16x32_bf16 v[244:247], v[52:55], v[20:23], v[244:247]
    v_perm_b32 v16, v131, v129, s61
    v_perm_b32 v17, v135, v133, s61
    v_perm_b32 v18, v87, v83, s61
    v_perm_b32 v19, v95, v91, s61
    v_mfma_f32_16x16x32_bf16 v[232:235], v[36:39], v[24:27], v[232:235]
    v_mfma_f32_16x16x32_bf16 v[248:251], v[52:55], v[24:27], v[248:251]
    buffer_load_dwordx4 v[80:83], v7, s[36:39], s72 offen offset:0
    buffer_load_dwordx4 v[84:87], v7, s[36:39], s72 offen offset:256
    buffer_load_dwordx4 v[88:91], v7, s[36:39], s72 offen offset:512
    buffer_load_dwordx4 v[92:95], v7, s[36:39], s72 offen offset:768
    v_mfma_f32_16x16x32_bf16 v[236:239], v[36:39], v[16:19], v[236:239]
    v_mfma_f32_16x16x32_bf16 v[252:255], v[52:55], v[16:19], v[252:255]
    v_lshl_add_u32 v2, v197, 6, v10
    buffer_load_dwordx4 v[52:55], v2, s[28:31], 0 offen
    s_add_u32 s72, s71, 16384
    s_waitcnt lgkmcnt(1)
    s_waitcnt vmcnt(15)
    s_mov_b64 vcc, s[8:9]
    v_cndmask_b32_dpp v128, v98, v96, vcc row_ror:8 row_mask:0xf bank_mask:0xf
    v_cndmask_b32_dpp v129, v99, v97, vcc row_ror:8 row_mask:0xf bank_mask:0xf
    v_cndmask_b32_dpp v130, v102, v100, vcc row_ror:8 row_mask:0xf bank_mask:0xf
    v_cndmask_b32_dpp v131, v103, v101, vcc row_ror:8 row_mask:0xf bank_mask:0xf
    v_cndmask_b32_dpp v132, v106, v104, vcc row_ror:8 row_mask:0xf bank_mask:0xf
    v_cndmask_b32_dpp v133, v107, v105, vcc row_ror:8 row_mask:0xf bank_mask:0xf
    v_cndmask_b32_dpp v134, v110, v108, vcc row_ror:8 row_mask:0xf bank_mask:0xf
    v_cndmask_b32_dpp v135, v111, v109, vcc row_ror:8 row_mask:0xf bank_mask:0xf
    s_mov_b64 vcc, s[10:11]
    v_cndmask_b32_dpp v98, v96, v98, vcc row_ror:8 row_mask:0xf bank_mask:0xf
    v_cndmask_b32_dpp v99, v97, v99, vcc row_ror:8 row_mask:0xf bank_mask:0xf
    v_cndmask_b32_dpp v102, v100, v102, vcc row_ror:8 row_mask:0xf bank_mask:0xf
    v_cndmask_b32_dpp v103, v101, v103, vcc row_ror:8 row_mask:0xf bank_mask:0xf
    v_cndmask_b32_dpp v106, v104, v106, vcc row_ror:8 row_mask:0xf bank_mask:0xf
    v_cndmask_b32_dpp v107, v105, v107, vcc row_ror:8 row_mask:0xf bank_mask:0xf
    v_cndmask_b32_dpp v110, v108, v110, vcc row_ror:8 row_mask:0xf bank_mask:0xf
    v_cndmask_b32_dpp v111, v109, v111, vcc row_ror:8 row_mask:0xf bank_mask:0xf
    v_perm_b32 v16, v130, v128, s60
    v_perm_b32 v17, v134, v132, s60
    v_perm_b32 v18, v102, v98, s60
    v_perm_b32 v19, v110, v106, s60
    v_perm_b32 v20, v130, v128, s61
    v_perm_b32 v21, v134, v132, s61
    v_perm_b32 v22, v102, v98, s61
    v_perm_b32 v23, v110, v106, s61
    v_mfma_f32_16x16x32_bf16 v[224:227], v[40:43], v[16:19], v[224:227]
    v_mfma_f32_16x16x32_bf16 v[240:243], v[56:59], v[16:19], v[240:243]
    v_perm_b32 v24, v131, v129, s60
    v_perm_b32 v25, v135, v133, s60
    v_perm_b32 v26, v103, v99, s60
    v_perm_b32 v27, v111, v107, s60
    v_mfma_f32_16x16x32_bf16 v[228:231], v[40:43], v[20:23], v[228:231]
    v_mfma_f32_16x16x32_bf16 v[244:247], v[56:59], v[20:23], v[244:247]
    v_perm_b32 v16, v131, v129, s61
    v_perm_b32 v17, v135, v133, s61
    v_perm_b32 v18, v103, v99, s61
    v_perm_b32 v19, v111, v107, s61
    v_mfma_f32_16x16x32_bf16 v[232:235], v[40:43], v[24:27], v[232:235]
    v_mfma_f32_16x16x32_bf16 v[248:251], v[56:59], v[24:27], v[248:251]
    buffer_load_dwordx4 v[96:99], v7, s[36:39], s72 offen offset:0
    buffer_load_dwordx4 v[100:103], v7, s[36:39], s72 offen offset:256
    buffer_load_dwordx4 v[104:107], v7, s[36:39], s72 offen offset:512
    buffer_load_dwordx4 v[108:111], v7, s[36:39], s72 offen offset:768
    v_mfma_f32_16x16x32_bf16 v[236:239], v[40:43], v[16:19], v[236:239]
    v_mfma_f32_16x16x32_bf16 v[252:255], v[56:59], v[16:19], v[252:255]
    v_lshl_add_u32 v2, v198, 6, v10
    buffer_load_dwordx4 v[56:59], v2, s[28:31], 0 offen
    s_add_u32 s72, s71, 24576
    s_waitcnt lgkmcnt(0)
    s_waitcnt vmcnt(15)
    s_mov_b64 vcc, s[8:9]
    v_cndmask_b32_dpp v128, v114, v112, vcc row_ror:8 row_mask:0xf bank_mask:0xf
    v_cndmask_b32_dpp v129, v115, v113, vcc row_ror:8 row_mask:0xf bank_mask:0xf
    v_cndmask_b32_dpp v130, v118, v116, vcc row_ror:8 row_mask:0xf bank_mask:0xf
    v_cndmask_b32_dpp v131, v119, v117, vcc row_ror:8 row_mask:0xf bank_mask:0xf
    v_cndmask_b32_dpp v132, v122, v120, vcc row_ror:8 row_mask:0xf bank_mask:0xf
    v_cndmask_b32_dpp v133, v123, v121, vcc row_ror:8 row_mask:0xf bank_mask:0xf
    v_cndmask_b32_dpp v134, v126, v124, vcc row_ror:8 row_mask:0xf bank_mask:0xf
    v_cndmask_b32_dpp v135, v127, v125, vcc row_ror:8 row_mask:0xf bank_mask:0xf
    s_mov_b64 vcc, s[10:11]
    v_cndmask_b32_dpp v114, v112, v114, vcc row_ror:8 row_mask:0xf bank_mask:0xf
    v_cndmask_b32_dpp v115, v113, v115, vcc row_ror:8 row_mask:0xf bank_mask:0xf
    v_cndmask_b32_dpp v118, v116, v118, vcc row_ror:8 row_mask:0xf bank_mask:0xf
    v_cndmask_b32_dpp v119, v117, v119, vcc row_ror:8 row_mask:0xf bank_mask:0xf
    v_cndmask_b32_dpp v122, v120, v122, vcc row_ror:8 row_mask:0xf bank_mask:0xf
    v_cndmask_b32_dpp v123, v121, v123, vcc row_ror:8 row_mask:0xf bank_mask:0xf
    v_cndmask_b32_dpp v126, v124, v126, vcc row_ror:8 row_mask:0xf bank_mask:0xf
    v_cndmask_b32_dpp v127, v125, v127, vcc row_ror:8 row_mask:0xf bank_mask:0xf
    v_perm_b32 v16, v130, v128, s60
    v_perm_b32 v17, v134, v132, s60
    v_perm_b32 v18, v118, v114, s60
    v_perm_b32 v19, v126, v122, s60
    v_perm_b32 v20, v130, v128, s61
    v_perm_b32 v21, v134, v132, s61
    v_perm_b32 v22, v118, v114, s61
    v_perm_b32 v23, v126, v122, s61
    v_mfma_f32_16x16x32_bf16 v[224:227], v[44:47], v[16:19], v[224:227]
    v_mfma_f32_16x16x32_bf16 v[240:243], v[60:63], v[16:19], v[240:243]
    v_perm_b32 v24, v131, v129, s60
    v_perm_b32 v25, v135, v133, s60
    v_perm_b32 v26, v119, v115, s60
    v_perm_b32 v27, v127, v123, s60
    v_mfma_f32_16x16x32_bf16 v[228:231], v[44:47], v[20:23], v[228:231]
    v_mfma_f32_16x16x32_bf16 v[244:247], v[60:63], v[20:23], v[244:247]
    v_perm_b32 v16, v131, v129, s61
    v_perm_b32 v17, v135, v133, s61
    v_perm_b32 v18, v119, v115, s61
    v_perm_b32 v19, v127, v123, s61
    v_mfma_f32_16x16x32_bf16 v[232:235], v[44:47], v[24:27], v[232:235]
    v_mfma_f32_16x16x32_bf16 v[248:251], v[60:63], v[24:27], v[248:251]
    buffer_load_dwordx4 v[112:115], v7, s[36:39], s72 offen offset:0
    buffer_load_dwordx4 v[116:119], v7, s[36:39], s72 offen offset:256
    buffer_load_dwordx4 v[120:123], v7, s[36:39], s72 offen offset:512
    buffer_load_dwordx4 v[124:127], v7, s[36:39], s72 offen offset:768
    v_mfma_f32_16x16x32_bf16 v[236:239], v[44:47], v[16:19], v[236:239]
    v_mfma_f32_16x16x32_bf16 v[252:255], v[60:63], v[16:19], v[252:255]
    v_lshl_add_u32 v2, v199, 6, v10
    buffer_load_dwordx4 v[60:63], v2, s[28:31], 0 offen
    s_add_u32 s71, s71, 131072
    s_cmp_eq_u32 s71, 786432
    s_cselect_b32 s71, 0, s71
    s_barrier
    ds_read_b128 v[32:35], v28
    ds_read_b128 v[36:39], v29
    ds_read_b128 v[40:43], v30
    ds_read_b128 v[44:47], v31
    s_mul_i32 s72, s57, 24576
    s_sub_u32 s72, 786432, s72
    v_lshrrev_b32 v2, 3, v5
    v_and_b32 v2, 1, v2
    v_lshlrev_b32 v2, 1, v2
    v_xor_b32 v2, v2, v6
    v_lshlrev_b32 v2, 4, v2
    v_add_u32 v3, s57, v5
    v_and_b32 v3, 3, v3
    v_and_b32 v4, 12, v5
    v_or_b32 v3, v3, v4
    v_lshl_add_u32 v28, v3, 6, v2
    s_lshl_b32 s63, s57, 10
    s_add_u32 s63, s63, 98304
    v_add_u32 v28, s63, v28
    s_waitcnt lgkmcnt(3)
    s_waitcnt vmcnt(15)
    s_mov_b64 vcc, s[8:9]
    v_cndmask_b32_dpp v128, v66, v64, vcc row_ror:8 row_mask:0xf bank_mask:0xf
    v_cndmask_b32_dpp v129, v67, v65, vcc row_ror:8 row_mask:0xf bank_mask:0xf
    v_cndmask_b32_dpp v130, v70, v68, vcc row_ror:8 row_mask:0xf bank_mask:0xf
    v_cndmask_b32_dpp v131, v71, v69, vcc row_ror:8 row_mask:0xf bank_mask:0xf
    v_cndmask_b32_dpp v132, v74, v72, vcc row_ror:8 row_mask:0xf bank_mask:0xf
    v_cndmask_b32_dpp v133, v75, v73, vcc row_ror:8 row_mask:0xf bank_mask:0xf
    v_cndmask_b32_dpp v134, v78, v76, vcc row_ror:8 row_mask:0xf bank_mask:0xf
    v_cndmask_b32_dpp v135, v79, v77, vcc row_ror:8 row_mask:0xf bank_mask:0xf
    s_mov_b64 vcc, s[10:11]
    v_cndmask_b32_dpp v66, v64, v66, vcc row_ror:8 row_mask:0xf bank_mask:0xf
    v_cndmask_b32_dpp v67, v65, v67, vcc row_ror:8 row_mask:0xf bank_mask:0xf
    v_cndmask_b32_dpp v70, v68, v70, vcc row_ror:8 row_mask:0xf bank_mask:0xf
    v_cndmask_b32_dpp v71, v69, v71, vcc row_ror:8 row_mask:0xf bank_mask:0xf
    v_cndmask_b32_dpp v74, v72, v74, vcc row_ror:8 row_mask:0xf bank_mask:0xf
    v_cndmask_b32_dpp v75, v73, v75, vcc row_ror:8 row_mask:0xf bank_mask:0xf
    v_cndmask_b32_dpp v78, v76, v78, vcc row_ror:8 row_mask:0xf bank_mask:0xf
    v_cndmask_b32_dpp v79, v77, v79, vcc row_ror:8 row_mask:0xf bank_mask:0xf
    v_perm_b32 v16, v130, v128, s60
    v_perm_b32 v17, v134, v132, s60
    v_perm_b32 v18, v70, v66, s60
    v_perm_b32 v19, v78, v74, s60
    v_perm_b32 v20, v130, v128, s61
    v_perm_b32 v21, v134, v132, s61
    v_perm_b32 v22, v70, v66, s61
    v_perm_b32 v23, v78, v74, s61
    v_mfma_f32_16x16x32_bf16 v[224:227], v[32:35], v[16:19], v[224:227]
    v_mfma_f32_16x16x32_bf16 v[240:243], v[48:51], v[16:19], v[240:243]
    v_perm_b32 v24, v131, v129, s60
    v_perm_b32 v25, v135, v133, s60
    v_perm_b32 v26, v71, v67, s60
    v_perm_b32 v27, v79, v75, s60
    v_mfma_f32_16x16x32_bf16 v[228:231], v[32:35], v[20:23], v[228:231]
    v_mfma_f32_16x16x32_bf16 v[244:247], v[48:51], v[20:23], v[244:247]
    v_perm_b32 v16, v131, v129, s61
    v_perm_b32 v17, v135, v133, s61
    v_perm_b32 v18, v71, v67, s61
    v_perm_b32 v19, v79, v75, s61
    v_mfma_f32_16x16x32_bf16 v[232:235], v[32:35], v[24:27], v[232:235]
    v_mfma_f32_16x16x32_bf16 v[248:251], v[48:51], v[24:27], v[248:251]
    buffer_load_dwordx4 v[64:67], v7, s[36:39], s72 offen offset:0
    buffer_load_dwordx4 v[68:71], v7, s[36:39], s72 offen offset:256
    buffer_load_dwordx4 v[72:75], v7, s[36:39], s72 offen offset:512
    buffer_load_dwordx4 v[76:79], v7, s[36:39], s72 offen offset:768
    v_mfma_f32_16x16x32_bf16 v[236:239], v[32:35], v[16:19], v[236:239]
    v_mfma_f32_16x16x32_bf16 v[252:255], v[48:51], v[16:19], v[252:255]
    v_lshl_add_u32 v2, v200, 6, v10
    buffer_load_dwordx4 v[48:51], v2, s[28:31], 0 offen
    v_add_u32 v12, 1, v12
    v_or_b32 v12, 0x80000000, v12
    buffer_load_dword v9, v11, s[16:19], 0 offen sc0 sc1
    s_waitcnt lgkmcnt(2)
    s_waitcnt vmcnt(16)
    s_mov_b64 vcc, s[8:9]
    v_cndmask_b32_dpp v128, v82, v80, vcc row_ror:8 row_mask:0xf bank_mask:0xf
    v_cndmask_b32_dpp v129, v83, v81, vcc row_ror:8 row_mask:0xf bank_mask:0xf
    v_cndmask_b32_dpp v130, v86, v84, vcc row_ror:8 row_mask:0xf bank_mask:0xf
    v_cndmask_b32_dpp v131, v87, v85, vcc row_ror:8 row_mask:0xf bank_mask:0xf
    v_cndmask_b32_dpp v132, v90, v88, vcc row_ror:8 row_mask:0xf bank_mask:0xf
    v_cndmask_b32_dpp v133, v91, v89, vcc row_ror:8 row_mask:0xf bank_mask:0xf
    v_cndmask_b32_dpp v134, v94, v92, vcc row_ror:8 row_mask:0xf bank_mask:0xf
    v_cndmask_b32_dpp v135, v95, v93, vcc row_ror:8 row_mask:0xf bank_mask:0xf
    s_mov_b64 vcc, s[10:11]
    v_cndmask_b32_dpp v82, v80, v82, vcc row_ror:8 row_mask:0xf bank_mask:0xf
    v_cndmask_b32_dpp v83, v81, v83, vcc row_ror:8 row_mask:0xf bank_mask:0xf
    v_cndmask_b32_dpp v86, v84, v86, vcc row_ror:8 row_mask:0xf bank_mask:0xf
    v_cndmask_b32_dpp v87, v85, v87, vcc row_ror:8 row_mask:0xf bank_mask:0xf
    v_cndmask_b32_dpp v90, v88, v90, vcc row_ror:8 row_mask:0xf bank_mask:0xf
    v_cndmask_b32_dpp v91, v89, v91, vcc row_ror:8 row_mask:0xf bank_mask:0xf
    v_cndmask_b32_dpp v94, v92, v94, vcc row_ror:8 row_mask:0xf bank_mask:0xf
    v_cndmask_b32_dpp v95, v93, v95, vcc row_ror:8 row_mask:0xf bank_mask:0xf
    v_perm_b32 v16, v130, v128, s60
    v_perm_b32 v17, v134, v132, s60
    v_perm_b32 v18, v86, v82, s60
    v_perm_b32 v19, v94, v90, s60
    v_perm_b32 v20, v130, v128, s61
    v_perm_b32 v21, v134, v132, s61
    v_perm_b32 v22, v86, v82, s61
    v_perm_b32 v23, v94, v90, s61
    v_mfma_f32_16x16x32_bf16 v[224:227], v[36:39], v[16:19], v[224:227]
    v_mfma_f32_16x16x32_bf16 v[240:243], v[52:55], v[16:19], v[240:243]
    v_perm_b32 v24, v131, v129, s60
    v_perm_b32 v25, v135, v133, s60
    v_perm_b32 v26, v87, v83, s60
    v_perm_b32 v27, v95, v91, s60
    v_mfma_f32_16x16x32_bf16 v[228:231], v[36:39], v[20:23], v[228:231]
    v_mfma_f32_16x16x32_bf16 v[244:247], v[52:55], v[20:23], v[244:247]
    v_perm_b32 v16, v131, v129, s61
    v_perm_b32 v17, v135, v133, s61
    v_perm_b32 v18, v87, v83, s61
    v_perm_b32 v19, v95, v91, s61
    v_mfma_f32_16x16x32_bf16 v[232:235], v[36:39], v[24:27], v[232:235]
    v_mfma_f32_16x16x32_bf16 v[248:251], v[52:55], v[24:27], v[248:251]
    s_nop 1
    v_mfma_f32_16x16x32_bf16 v[236:239], v[36:39], v[16:19], v[236:239]
    v_mfma_f32_16x16x32_bf16 v[252:255], v[52:55], v[16:19], v[252:255]
    s_waitcnt lgkmcnt(1)
    s_waitcnt vmcnt(11)
    s_mov_b64 vcc, s[8:9]
    v_cndmask_b32_dpp v128, v98, v96, vcc row_ror:8 row_mask:0xf bank_mask:0xf
    v_cndmask_b32_dpp v129, v99, v97, vcc row_ror:8 row_mask:0xf bank_mask:0xf
    v_cndmask_b32_dpp v130, v102, v100, vcc row_ror:8 row_mask:0xf bank_mask:0xf
    v_cndmask_b32_dpp v131, v103, v101, vcc row_ror:8 row_mask:0xf bank_mask:0xf
    v_cndmask_b32_dpp v132, v106, v104, vcc row_ror:8 row_mask:0xf bank_mask:0xf
    v_cndmask_b32_dpp v133, v107, v105, vcc row_ror:8 row_mask:0xf bank_mask:0xf
    v_cndmask_b32_dpp v134, v110, v108, vcc row_ror:8 row_mask:0xf bank_mask:0xf
    v_cndmask_b32_dpp v135, v111, v109, vcc row_ror:8 row_mask:0xf bank_mask:0xf
    s_mov_b64 vcc, s[10:11]
    v_cndmask_b32_dpp v98, v96, v98, vcc row_ror:8 row_mask:0xf bank_mask:0xf
    v_cndmask_b32_dpp v99, v97, v99, vcc row_ror:8 row_mask:0xf bank_mask:0xf
    v_cndmask_b32_dpp v102, v100, v102, vcc row_ror:8 row_mask:0xf bank_mask:0xf
    v_cndmask_b32_dpp v103, v101, v103, vcc row_ror:8 row_mask:0xf bank_mask:0xf
    v_cndmask_b32_dpp v106, v104, v106, vcc row_ror:8 row_mask:0xf bank_mask:0xf
    v_cndmask_b32_dpp v107, v105, v107, vcc row_ror:8 row_mask:0xf bank_mask:0xf
    v_cndmask_b32_dpp v110, v108, v110, vcc row_ror:8 row_mask:0xf bank_mask:0xf
    v_cndmask_b32_dpp v111, v109, v111, vcc row_ror:8 row_mask:0xf bank_mask:0xf
    v_perm_b32 v16, v130, v128, s60
    v_perm_b32 v17, v134, v132, s60
    v_perm_b32 v18, v102, v98, s60
    v_perm_b32 v19, v110, v106, s60
    v_perm_b32 v20, v130, v128, s61
    v_perm_b32 v21, v134, v132, s61
    v_perm_b32 v22, v102, v98, s61
    v_perm_b32 v23, v110, v106, s61
    v_mfma_f32_16x16x32_bf16 v[224:227], v[40:43], v[16:19], v[224:227]
    v_mfma_f32_16x16x32_bf16 v[240:243], v[56:59], v[16:19], v[240:243]
    v_perm_b32 v24, v131, v129, s60
    v_perm_b32 v25, v135, v133, s60
    v_perm_b32 v26, v103, v99, s60
    v_perm_b32 v27, v111, v107, s60
    v_mfma_f32_16x16x32_bf16 v[228:231], v[40:43], v[20:23], v[228:231]
    v_mfma_f32_16x16x32_bf16 v[244:247], v[56:59], v[20:23], v[244:247]
    v_perm_b32 v16, v131, v129, s61
    v_perm_b32 v17, v135, v133, s61
    v_perm_b32 v18, v103, v99, s61
    v_perm_b32 v19, v111, v107, s61
    v_mfma_f32_16x16x32_bf16 v[232:235], v[40:43], v[24:27], v[232:235]
    v_mfma_f32_16x16x32_bf16 v[248:251], v[56:59], v[24:27], v[248:251]
    s_nop 1
    v_mfma_f32_16x16x32_bf16 v[236:239], v[40:43], v[16:19], v[236:239]
    v_mfma_f32_16x16x32_bf16 v[252:255], v[56:59], v[16:19], v[252:255]
    s_waitcnt lgkmcnt(0)
    s_waitcnt vmcnt(6)
    s_mov_b64 vcc, s[8:9]
    v_cndmask_b32_dpp v128, v114, v112, vcc row_ror:8 row_mask:0xf bank_mask:0xf
    v_cndmask_b32_dpp v129, v115, v113, vcc row_ror:8 row_mask:0xf bank_mask:0xf
    v_cndmask_b32_dpp v130, v118, v116, vcc row_ror:8 row_mask:0xf bank_mask:0xf
    v_cndmask_b32_dpp v131, v119, v117, vcc row_ror:8 row_mask:0xf bank_mask:0xf
    v_cndmask_b32_dpp v132, v122, v120, vcc row_ror:8 row_mask:0xf bank_mask:0xf
    v_cndmask_b32_dpp v133, v123, v121, vcc row_ror:8 row_mask:0xf bank_mask:0xf
    v_cndmask_b32_dpp v134, v126, v124, vcc row_ror:8 row_mask:0xf bank_mask:0xf
    v_cndmask_b32_dpp v135, v127, v125, vcc row_ror:8 row_mask:0xf bank_mask:0xf
    s_mov_b64 vcc, s[10:11]
    v_cndmask_b32_dpp v114, v112, v114, vcc row_ror:8 row_mask:0xf bank_mask:0xf
    v_cndmask_b32_dpp v115, v113, v115, vcc row_ror:8 row_mask:0xf bank_mask:0xf
    v_cndmask_b32_dpp v118, v116, v118, vcc row_ror:8 row_mask:0xf bank_mask:0xf
    v_cndmask_b32_dpp v119, v117, v119, vcc row_ror:8 row_mask:0xf bank_mask:0xf
    v_cndmask_b32_dpp v122, v120, v122, vcc row_ror:8 row_mask:0xf bank_mask:0xf
    v_cndmask_b32_dpp v123, v121, v123, vcc row_ror:8 row_mask:0xf bank_mask:0xf
    v_cndmask_b32_dpp v126, v124, v126, vcc row_ror:8 row_mask:0xf bank_mask:0xf
    v_cndmask_b32_dpp v127, v125, v127, vcc row_ror:8 row_mask:0xf bank_mask:0xf
    v_perm_b32 v16, v130, v128, s60
    v_perm_b32 v17, v134, v132, s60
    v_perm_b32 v18, v118, v114, s60
    v_perm_b32 v19, v126, v122, s60
    v_perm_b32 v20, v130, v128, s61
    v_perm_b32 v21, v134, v132, s61
    v_perm_b32 v22, v118, v114, s61
    v_perm_b32 v23, v126, v122, s61
    v_mfma_f32_16x16x32_bf16 v[224:227], v[44:47], v[16:19], v[224:227]
    v_mfma_f32_16x16x32_bf16 v[240:243], v[60:63], v[16:19], v[240:243]
    v_perm_b32 v24, v131, v129, s60
    v_perm_b32 v25, v135, v133, s60
    v_perm_b32 v26, v119, v115, s60
    v_perm_b32 v27, v127, v123, s60
    v_mfma_f32_16x16x32_bf16 v[228:231], v[44:47], v[20:23], v[228:231]
    v_mfma_f32_16x16x32_bf16 v[244:247], v[60:63], v[20:23], v[244:247]
    v_perm_b32 v16, v131, v129, s61
    v_perm_b32 v17, v135, v133, s61
    v_perm_b32 v18, v119, v115, s61
    v_perm_b32 v19, v127, v123, s61
    v_mfma_f32_16x16x32_bf16 v[232:235], v[44:47], v[24:27], v[232:235]
    v_mfma_f32_16x16x32_bf16 v[248:251], v[60:63], v[24:27], v[248:251]
    s_nop 1
    v_mfma_f32_16x16x32_bf16 v[236:239], v[44:47], v[16:19], v[236:239]
    v_mfma_f32_16x16x32_bf16 v[252:255], v[60:63], v[16:19], v[252:255]
    s_barrier
    ds_read_b128 v[32:35], v28
    s_waitcnt lgkmcnt(0)
    s_waitcnt vmcnt(1)
    s_mov_b64 vcc, s[8:9]
    v_cndmask_b32_dpp v128, v66, v64, vcc row_ror:8 row_mask:0xf bank_mask:0xf
    v_cndmask_b32_dpp v129, v67, v65, vcc row_ror:8 row_mask:0xf bank_mask:0xf
    v_cndmask_b32_dpp v130, v70, v68, vcc row_ror:8 row_mask:0xf bank_mask:0xf
    v_cndmask_b32_dpp v131, v71, v69, vcc row_ror:8 row_mask:0xf bank_mask:0xf
    v_cndmask_b32_dpp v132, v74, v72, vcc row_ror:8 row_mask:0xf bank_mask:0xf
    v_cndmask_b32_dpp v133, v75, v73, vcc row_ror:8 row_mask:0xf bank_mask:0xf
    v_cndmask_b32_dpp v134, v78, v76, vcc row_ror:8 row_mask:0xf bank_mask:0xf
    v_cndmask_b32_dpp v135, v79, v77, vcc row_ror:8 row_mask:0xf bank_mask:0xf
    s_mov_b64 vcc, s[10:11]
    v_cndmask_b32_dpp v66, v64, v66, vcc row_ror:8 row_mask:0xf bank_mask:0xf
    v_cndmask_b32_dpp v67, v65, v67, vcc row_ror:8 row_mask:0xf bank_mask:0xf
    v_cndmask_b32_dpp v70, v68, v70, vcc row_ror:8 row_mask:0xf bank_mask:0xf
    v_cndmask_b32_dpp v71, v69, v71, vcc row_ror:8 row_mask:0xf bank_mask:0xf
    v_cndmask_b32_dpp v74, v72, v74, vcc row_ror:8 row_mask:0xf bank_mask:0xf
    v_cndmask_b32_dpp v75, v73, v75, vcc row_ror:8 row_mask:0xf bank_mask:0xf
    v_cndmask_b32_dpp v78, v76, v78, vcc row_ror:8 row_mask:0xf bank_mask:0xf
    v_cndmask_b32_dpp v79, v77, v79, vcc row_ror:8 row_mask:0xf bank_mask:0xf
    v_perm_b32 v16, v130, v128, s60
    v_perm_b32 v17, v134, v132, s60
    v_perm_b32 v18, v70, v66, s60
    v_perm_b32 v19, v78, v74, s60
    v_perm_b32 v20, v130, v128, s61
    v_perm_b32 v21, v134, v132, s61
    v_perm_b32 v22, v70, v66, s61
    v_perm_b32 v23, v78, v74, s61
    v_mfma_f32_16x16x32_bf16 v[224:227], v[32:35], v[16:19], v[224:227]
    v_mfma_f32_16x16x32_bf16 v[240:243], v[48:51], v[16:19], v[240:243]
    v_perm_b32 v24, v131, v129, s60
    v_perm_b32 v25, v135, v133, s60
    v_perm_b32 v26, v71, v67, s60
    v_perm_b32 v27, v79, v75, s60
    v_mfma_f32_16x16x32_bf16 v[228:231], v[32:35], v[20:23], v[228:231]
    v_mfma_f32_16x16x32_bf16 v[244:247], v[48:51], v[20:23], v[244:247]
    v_perm_b32 v16, v131, v129, s61
    v_perm_b32 v17, v135, v133, s61
    v_perm_b32 v18, v71, v67, s61
    v_perm_b32 v19, v79, v75, s61
    v_mfma_f32_16x16x32_bf16 v[232:235], v[32:35], v[24:27], v[232:235]
    v_mfma_f32_16x16x32_bf16 v[248:251], v[48:51], v[24:27], v[248:251]
    s_nop 1
    v_mfma_f32_16x16x32_bf16 v[236:239], v[32:35], v[16:19], v[236:239]
    v_mfma_f32_16x16x32_bf16 v[252:255], v[48:51], v[16:19], v[252:255]
    v_lshlrev_b32 v2, 4, v1
    s_lshl_b32 s63, s57, 13
    s_add_u32 s63, s63, 125696
    v_add_u32 v2, s63, v2
    s_nop 5
    ds_write_b128 v2, v[224:227] offset:0
    ds_write_b128 v2, v[228:231] offset:1024
    ds_write_b128 v2, v[232:235] offset:2048
    ds_write_b128 v2, v[236:239] offset:3072
    ds_write_b128 v2, v[240:243] offset:4096
    ds_write_b128 v2, v[244:247] offset:5120
    ds_write_b128 v2, v[248:251] offset:6144
    ds_write_b128 v2, v[252:255] offset:7168
    v_mov_b32 v56, 0
L_gelu:
    s_lshr_b32 s63, s3, 2
    s_lshl_b32 s63, s63, 12
    s_lshl_b32 s68, s57, 8
    s_add_u32 s63, s63, s68
    s_add_u32 s63, s63, 125696
    v_lshlrev_b32 v2, 4, v5
    v_lshl_add_u32 v2, v6, 10, v2
    v_add_u32 v2, s63, v2
    v_lshlrev_b32 v13, 16, v13
    v_lshlrev_b32 v14, 16, v14
    s_mov_b32 s64, 0x3d372713
    s_mov_b32 s65, 0xc0135761
    s_cmp_ge_u32 s3, 4
    s_cselect_b32 s63, s59, s56
    s_lshl_b32 s68, s57, 2
    s_add_u32 s63, s63, s68
    v_and_b32 v3, 3, v1
    s_lshl_b32 s68, s63, 5
    v_lshl_add_u32 v27, v3, 3, s68
    s_lshl_b32 s68, s63, 1
    v_lshl_add_u32 v8, v3, 1, s68
    s_waitcnt lgkmcnt(0)
    s_barrier
    ds_read_b128 v[64:67], v2 offset:0
    ds_read_b128 v[68:71], v2 offset:8192
    ds_read_b128 v[72:75], v2 offset:16384
    ds_read_b128 v[76:79], v2 offset:24576
    s_waitcnt lgkmcnt(2)
    v_add_f32 v64, v64, v68
    v_add_f32 v65, v65, v69
    v_add_f32 v66, v66, v70
    v_add_f32 v67, v67, v71
    s_waitcnt lgkmcnt(0)
    v_add_f32 v72, v72, v76
    v_add_f32 v73, v73, v77
    v_add_f32 v74, v74, v78
    v_add_f32 v75, v75, v79
    v_add_f32 v64, v64, v13
    v_add_f32 v65, v65, v13
    v_add_f32 v66, v66, v13
    v_add_f32 v67, v67, v13
    v_add_f32 v64, v64, v72
    v_add_f32 v65, v65, v73
    v_add_f32 v66, v66, v74
    v_add_f32 v67, v67, v75
    v_mul_f32 v90, v64, v64
    v_mul_f32 v91, v65, v65
    v_mul_f32 v92, v66, v66
    v_mul_f32 v93, v67, v67
    v_fma_f32 v90, v90, s64, 1.0
    v_fma_f32 v91, v91, s64, 1.0
    v_fma_f32 v92, v92, s64, 1.0
    v_fma_f32 v93, v93, s64, 1.0
    v_mul_f32 v90, v90, v64
    v_mul_f32 v91, v91, v65
    v_mul_f32 v92, v92, v66
    v_mul_f32 v93, v93, v67
    v_mul_f32 v90, s65, v90
    v_mul_f32 v91, s65, v91
    v_mul_f32 v92, s65, v92
    v_mul_f32 v93, s65, v93
    v_exp_f32 v90, v90
    v_exp_f32 v91, v91
    v_exp_f32 v92, v92
    v_exp_f32 v93, v93
    v_mul_f32 v64, v64, v14
    v_mul_f32 v65, v65, v14
    v_mul_f32 v66, v66, v14
    v_mul_f32 v67, v67, v14
    v_add_f32 v90, 1.0, v90
    v_add_f32 v91, 1.0, v91
    v_add_f32 v92, 1.0, v92
    v_add_f32 v93, 1.0, v93
    v_rcp_f32 v90, v90
    v_rcp_f32 v91, v91
    v_rcp_f32 v92, v92
    v_rcp_f32 v93, v93
    s_cmp_ge_u32 s3, 4
    s_cbranch_scc1 L_nop2
    v_fma_f32 v64, v64, v90, v52
    v_fma_f32 v65, v65, v91, v53
    v_fma_f32 v66, v66, v92, v54
    v_fma_f32 v67, v67, v93, v55
    s_branch L_red
L_nop2:
    v_mul_f32 v64, v64, v90
    v_mul_f32 v65, v65, v91
    v_mul_f32 v66, v66, v92
    v_mul_f32 v67, v67, v93
L_red:
    s_nop 1
    v_add_f32_dpp v64, v64, v64 row_ror:8 row_mask:0xf bank_mask:0xf
    v_add_f32_dpp v65, v65, v65 row_ror:8 row_mask:0xf bank_mask:0xf
    v_add_f32_dpp v66, v66, v66 row_ror:8 row_mask:0xf bank_mask:0xf
    v_add_f32_dpp v67, v67, v67 row_ror:8 row_mask:0xf bank_mask:0xf
    s_nop 1
    v_add_f32_dpp v64, v64, v64 row_ror:4 row_mask:0xf bank_mask:0xf
    v_add_f32_dpp v65, v65, v65 row_ror:4 row_mask:0xf bank_mask:0xf
    v_add_f32_dpp v66, v66, v66 row_ror:4 row_mask:0xf bank_mask:0xf
    v_add_f32_dpp v67, v67, v67 row_ror:4 row_mask:0xf bank_mask:0xf
    s_nop 1
    v_add_f32_dpp v64, v64, v64 row_ror:2 row_mask:0xf bank_mask:0xf
    v_add_f32_dpp v65, v65, v65 row_ror:2 row_mask:0xf bank_mask:0xf
    v_add_f32_dpp v66, v66, v66 row_ror:2 row_mask:0xf bank_mask:0xf
    v_add_f32_dpp v67, v67, v67 row_ror:2 row_mask:0xf bank_mask:0xf
    s_nop 1
    v_add_f32_dpp v64, v64, v64 row_ror:1 row_mask:0xf bank_mask:0xf
    v_add_f32_dpp v65, v65, v65 row_ror:1 row_mask:0xf bank_mask:0xf
    v_add_f32_dpp v66, v66, v66 row_ror:1 row_mask:0xf bank_mask:0xf
    v_add_f32_dpp v67, v67, v67 row_ror:1 row_mask:0xf bank_mask:0xf
    s_nop 1
    v_add_f32_dpp v64, v64, v64 row_bcast:15 row_mask:0xa bank_mask:0xf
    v_add_f32_dpp v65, v65, v65 row_bcast:15 row_mask:0xa bank_mask:0xf
    v_add_f32_dpp v66, v66, v66 row_bcast:15 row_mask:0xa bank_mask:0xf
    v_add_f32_dpp v67, v67, v67 row_bcast:15 row_mask:0xa bank_mask:0xf
    s_nop 1
    v_add_f32_dpp v64, v64, v64 row_bcast:31 row_mask:0xc bank_mask:0xf
    v_add_f32_dpp v65, v65, v65 row_bcast:31 row_mask:0xc bank_mask:0xf
    v_add_f32_dpp v66, v66, v66 row_bcast:31 row_mask:0xc bank_mask:0xf
    v_add_f32_dpp v67, v67, v67 row_bcast:31 row_mask:0xc bank_mask:0xf
    v_cmp_eq_u32 vcc, 1, v3
    s_waitcnt vmcnt(0)
    v_readfirstlane_b32 s63, v9
    v_cndmask_b32 v16, v64, v65, vcc
    v_cmp_eq_u32 vcc, 2, v3
    s_cmp_lg_u32 s63, 0
    s_nop 0
    v_cndmask_b32 v16, v16, v66, vcc
    v_cmp_eq_u32 vcc, 3, v3
    s_cbranch_scc1 L_havenonce
    v_mov_b32 v58, v12
    v_mov_b32 v59, 0
    s_mov_b64 exec, 1
    buffer_atomic_cmpswap v[58:59], v11, s[16:19], 0 offen sc0 sc1
    s_waitcnt vmcnt(0)
    v_readfirstlane_b32 s63, v58
    v_readfirstlane_b32 s68, v12
    s_nop 1
    s_cmp_eq_u32 s63, 0
    s_cselect_b32 s63, s68, s63
    s_mov_b64 exec, -1
L_havenonce:
    s_nop 0
    v_cndmask_b32 v16, v16, v67, vcc
    s_mov_b32 exec_lo, 0
    s_mov_b32 exec_hi, 0x000f0000
    v_add_f32 v16, v16, v56
    v_mov_b32 v17, s63
    s_nop 0
    v_mov_b32 v26, v16
    buffer_atomic_swap_x2 v[16:17], v27, s[12:15], 0 offen sc0 sc1
    s_waitcnt vmcnt(0)
    v_cmp_eq_u32 vcc, s63, v17
    s_and_saveexec_b64 s[64:65], vcc
    s_cbranch_execz L_fin1
    v_add_f32 v16, v16, v26
    v_cvt_pk_bf16_f32 v16, v16, v16
    buffer_store_short v16, v8, s[40:43], 0 offen
L_fin1:
L_end:
    s_endpgm
.section .rodata,"a"
.p2align 6
.amdhsa_kernel standalone__deep_cross_pnn__recsys_kernel
  .amdhsa_next_free_vgpr 256
  .amdhsa_next_free_sgpr 102
  .amdhsa_accum_offset 256
  .amdhsa_group_segment_fixed_size 0
  .amdhsa_kernarg_size 80
  .amdhsa_user_sgpr_count 2
  .amdhsa_user_sgpr_kernarg_segment_ptr 1
  .amdhsa_system_sgpr_workgroup_id_x 1
.end_amdhsa_kernel
```
